```python
import torch

def _softmax(x, axis=-1):
    return torch.softmax(x, dim=axis)
def _gelu(x):
    return torch.nn.functional.gelu(x, approximate="tanh")
def _silu(x):
    return torch.nn.functional.silu(x)
def _sigmoid(x):
    return torch.sigmoid(x)
def _layernorm(x, axis=-1, eps=1e-5):
    m = x.mean(dim=axis, keepdim=True)
    v = x.var(dim=axis, keepdim=True, unbiased=False)
    return (x - m) / torch.sqrt(v + eps)
def _scatter_add(tgt, idx, src, axis=0):
    return tgt.clone().index_add_(axis, idx, src)
def _segment_sum(src, seg, n):
    out = torch.zeros((n,) + src.shape[1:], dtype=src.dtype)
    return out.index_add_(0, seg, src)
def _pad(x, pw):
    flat = tuple(v for pair in reversed(pw) for v in pair)
    return torch.nn.functional.pad(x, flat)

kernel_name = 'standalone__weight_only_int_quip__prompt'

def setup_inputs():

    _w = (lambda a: (lambda t: t.to(torch.bfloat16) if t.is_floating_point() else t)(torch.as_tensor(a)))
    B, S, D, F = 1, 2048, 640, 1536
    G = 32 if 32 > 0 else D
    D = (D // G) * G
    ng = D // G
    bits = 3 if 3 > 0 else 4
    qmax = 1 << bits
    qw = torch.randint(0, qmax, (D, F)).to(torch.int32)
    U, _ = (lambda *_a, **_k: torch.linalg.qr(*[torch.as_tensor(_x).float() for _x in _a], **_k))((lambda *s: torch.randn(*s, dtype=torch.bfloat16) * 0.05)(D, D))
    V, _ = (lambda *_a, **_k: torch.linalg.qr(*[torch.as_tensor(_x).float() for _x in _a], **_k))((lambda *s: torch.randn(*s, dtype=torch.bfloat16) * 0.05)(F, F))
    return {
        "x": _w((lambda *s: torch.randn(*s, dtype=torch.bfloat16) * 0.05)(B, S, D)),
        "qw": _w(qw),
        "scales": _w(torch.abs((lambda *s: torch.randn(*s, dtype=torch.bfloat16) * 0.05)(ng, F)) * 0.02 + 0.005),
        "zeros": _w(torch.full((ng, F), qmax / 2.0, dtype=float)),
        "U": _w(U.to(float)),
        "V": _w(V.to(float)),
    }

def reference(x, qw, scales, zeros, U, V):
    B, S, D = x.shape
    ng, F = scales.shape
    G = D // ng
    s = (lambda x, n, axis: torch.repeat_interleave(x, n, dim=axis))(scales, G, axis=0)
    z = (lambda x, n, axis: torch.repeat_interleave(x, n, dim=axis))(zeros, G, axis=0)
    wq = ((lambda x, dt: x.to(dt))(qw, x.dtype) - z) * s
    xr = torch.einsum("bsd,de->bse", x, U)
    h  = torch.einsum("bse,ef->bsf", xr, wq)
    y  = torch.einsum("bsf,fg->bsg", h, V)
    return y
```

```asm
; @launch grid=(256,1,1) block=(512,1,1) lds=156672
.amdgcn_target "amdgcn-amd-amdhsa--gfx950"
.text
.globl standalone__weight_only_int_quip__prompt_kernel
.p2align 8
.type standalone__weight_only_int_quip__prompt_kernel,@function
standalone__weight_only_int_quip__prompt_kernel:
    s_cmp_ge_u32 s2, 256
    s_cbranch_scc1 K_EXIT
    s_getpc_b64 s[4:5]
P1_PC:
    v_lshlrev_b32 v3, 7, v0
    v_min_u32 v3, CODE_END-P1_PC-4, v3
    global_load_dword v250, v3, s[4:5]
    s_load_dwordx2 s[8:9], s[0:1], 8
    s_load_dwordx2 s[12:13], s[0:1], 40
    s_load_dwordx2 s[16:17], s[0:1], 16
    s_load_dwordx2 s[20:21], s[0:1], 24
    s_load_dwordx2 s[28:29], s[0:1], 0
    s_load_dwordx2 s[32:33], s[0:1], 32
    s_load_dwordx2 s[24:25], s[0:1], 64
    s_load_dwordx2 s[92:93], s[0:1], 56
    s_load_dwordx2 s[96:97], s[0:1], 48
    v_and_b32 v1, 63, v0
    v_lshrrev_b32 v2, 6, v0
    s_lshr_b32 s3, s2, 3
    v_readfirstlane_b32 s36, v2
    s_and_b32 s37, s2, 7
    s_cmp_lg_u32 s36, 7
    s_cbranch_scc1 P1_NOPF
    v_mov_b32 v2, 0
    v_mov_b32 v3, 0
    v_mov_b32 v4, 155648
    ds_write_b64 v4, v[2:3]
    ds_write_b64 v4, v[2:3] offset:8
P1_NOPF:
    s_mov_b32 s11, 0x00020000
    s_mov_b32 s15, 0x00020000
    s_mov_b32 s27, 0x00020000
    s_mov_b32 s26, 8912896
    s_movk_i32 s94, 256
    s_mov_b32 s95, 0x00020000
    s_mov_b32 s98, 6291456
    s_mov_b32 s99, 0x00020000
    v_lshlrev_b32 v5, 4, v1
    s_mov_b32 s62, 0
    s_cmp_ge_u32 s3, 21
    s_cbranch_scc1 P1_XR
    s_mul_i32 s4, s3, 171
    s_lshr_b32 s4, s4, 9
    s_mul_i32 s5, s4, 3
    s_sub_u32 s57, s3, s5
    s_lshr_b32 s6, s37, 2
    s_mul_i32 s6, s6, 7
    s_add_u32 s40, s6, s4
    s_and_b32 s6, s37, 1
    s_mul_i32 s6, s6, 3
    s_add_u32 s6, s6, s57
    s_bfe_u32 s58, s37, 0x10001
    s_lshl1_add_u32 s41, s6, s58
    s_mul_i32 s42, s40, 3
    s_sub_u32 s4, s36, 4
    s_cmp_lt_u32 s4, 3
    s_cbranch_scc1 W2_DEQ
    s_mov_b32 s14, 4718592
    v_lshrrev_b32 v2, 4, v1
    v_and_b32 v3, 15, v1
    v_lshlrev_b32 v4, 1, v2
    v_xor_b32 v3, v3, v4
    v_lshlrev_b32 v3, 4, v3
    v_mul_u32_u24 v4, 0xc00, v2
    v_add_u32 v6, v3, v4
    v_add_u32 v7, 11264, v6
    v_xor_b32 v3, 0x80, v6
    v_add_u32 v8, 22528, v3
    v_add_u32 v9, 33792, v3
    s_lshl_b32 s43, s41, 8
    s_mul_i32 s4, s58, 2359296
    s_add_u32 s43, s43, s4
    s_cmp_lt_u32 s36, 4
    s_cbranch_scc1 W2_MFMA
    v_add_u32 v10, 49152, v6
    v_add_u32 v11, 49152, v7
    v_add_u32 v12, 49152, v8
    v_add_u32 v13, 49152, v9
    v_add_u32 v14, 98304, v6
    v_add_u32 v15, 98304, v7
    v_add_u32 v16, 98304, v8
    v_add_u32 v17, 98304, v9
    v_add_u32 v18, 147456, v6
    v_add_u32 v19, 147456, v7
    v_add_u32 v20, 147456, v8
    v_add_u32 v21, 147456, v9
    v_and_b32 v40, 7, v1
    v_lshlrev_b32 v40, 2, v40
    s_mov_b32 m0, 32768
    s_mov_b32 s49, 2
    s_add_u32 s43, s43, 393216
    s_lshl_b32 s48, s58, 9
    s_sub_u32 s48, 4292804864, s48
    s_waitcnt lgkmcnt(0)
W2L_LOOP:
    s_cmp_lg_u32 s49, 12
    s_cbranch_scc1 W2L_NG
    buffer_load_dword v42, v40, s[92:95], 0 offen sc1
W2L_NG:
    buffer_load_dwordx4 v6, s[12:15], s43 offen offset:0 lds
    buffer_load_dwordx4 v7, s[12:15], s43 offen offset:1024 lds
    buffer_load_dwordx4 v8, s[12:15], s43 offen offset:2048 lds
    buffer_load_dwordx4 v9, s[12:15], s43 offen offset:3072 lds
    s_add_u32 m0, m0, 4096
    s_nop 0
    buffer_load_dwordx4 v10, s[12:15], s43 offen offset:0 lds
    buffer_load_dwordx4 v11, s[12:15], s43 offen offset:1024 lds
    buffer_load_dwordx4 v12, s[12:15], s43 offen offset:2048 lds
    buffer_load_dwordx4 v13, s[12:15], s43 offen offset:3072 lds
    s_add_u32 m0, m0, 4096
    s_nop 0
    buffer_load_dwordx4 v14, s[12:15], s43 offen offset:0 lds
    buffer_load_dwordx4 v15, s[12:15], s43 offen offset:1024 lds
    buffer_load_dwordx4 v16, s[12:15], s43 offen offset:2048 lds
    buffer_load_dwordx4 v17, s[12:15], s43 offen offset:3072 lds
    s_add_u32 m0, m0, 4096
    s_waitcnt vmcnt(58)
    buffer_load_dwordx4 v18, s[12:15], s43 offen offset:0 lds
    buffer_load_dwordx4 v19, s[12:15], s43 offen offset:1024 lds
    buffer_load_dwordx4 v20, s[12:15], s43 offen offset:2048 lds
    buffer_load_dwordx4 v21, s[12:15], s43 offen offset:3072 lds
    s_add_u32 m0, m0, 4096
    s_cmp_ge_u32 m0, 81920
    s_cselect_b32 m0, 0, m0
    s_cmp_eq_u32 s49, 11
    s_cselect_b32 s4, s48, 196608
    s_add_u32 s43, s43, s4
    s_cmp_gt_u32 s49, 3
    s_cbranch_scc1 W2L_SY
    s_cmp_lt_u32 s49, 3
    s_cbranch_scc1 W2L_BB
    s_setprio 3
W2L_SY:
    s_waitcnt vmcnt(48)
    s_cmp_lg_u32 s49, 14
    s_cbranch_scc1 W2L_G_X
    v_cmp_ne_u32 vcc, 0, v42
    s_cmp_eq_u64 vcc, -1
    s_cbranch_scc0 W2L_GS
W2L_G_X:
W2L_BB:
    s_barrier
W2L_NB:
    s_add_u32 s49, s49, 1
    s_cmp_lt_u32 s49, 15
    s_cbranch_scc1 W2L_LOOP
    s_mov_b32 s47, 0
W2L2:
    buffer_load_dwordx4 v6, s[12:15], s43 offen offset:0 lds
    buffer_load_dwordx4 v7, s[12:15], s43 offen offset:1024 lds
    buffer_load_dwordx4 v8, s[12:15], s43 offen offset:2048 lds
    buffer_load_dwordx4 v9, s[12:15], s43 offen offset:3072 lds
    s_add_u32 m0, m0, 4096
    s_nop 0
    buffer_load_dwordx4 v10, s[12:15], s43 offen offset:0 lds
    buffer_load_dwordx4 v11, s[12:15], s43 offen offset:1024 lds
    buffer_load_dwordx4 v12, s[12:15], s43 offen offset:2048 lds
    buffer_load_dwordx4 v13, s[12:15], s43 offen offset:3072 lds
    s_add_u32 m0, m0, 12288
    s_cmp_ge_u32 m0, 81920
    s_cselect_b32 m0, s47, m0
    s_add_u32 s43, s43, 196608
    s_cmp_eq_u32 s49, 15
    s_waitcnt vmcnt(40)
    s_cbranch_scc1 W2L2_S
    s_cmp_eq_u32 s49, 16
    s_waitcnt vmcnt(32)
    s_cbranch_scc1 W2L2_S
    s_waitcnt vmcnt(24)
W2L2_S:
    s_barrier
    s_add_u32 s49, s49, 1
    s_cmp_lt_u32 s49, 24
    s_cbranch_scc1 W2L2
    s_setprio 0
    s_waitcnt vmcnt(16)
    s_barrier
    s_and_b32 s38, s37, 3
    s_lshl_b32 s38, s38, 2
    s_and_b32 s39, s3, 3
    s_add_u32 s38, s38, s39
    s_lshr_b32 s39, s37, 2
    s_lshl_b32 s39, s39, 3
    s_lshr_b32 s4, s3, 2
    s_add_u32 s39, s39, s4
    s_lshl_b32 s45, s38, 4
    s_add_u32 s45, s45, s39
    s_lshl_b32 s45, s45, 7
    s_add_u32 s44, s45, 4620288
    s_add_u32 s45, s45, 4587520
    s_max_u32 s4, s36, 5
    s_mul_i32 s4, s4, 32
    s_add_u32 s44, s44, s4
    s_sub_u32 s44, s44, 160
    v_mov_b32 v4, 155648
    v_mov_b32 v3, 1
    s_waitcnt vmcnt(8)
    s_barrier
    s_waitcnt vmcnt(0)
    s_barrier
    s_buffer_load_dword s62, s[24:27], s44 glc
    s_barrier
    s_branch P2_MM
W2L_GS:
    s_mov_b32 s7, 40000
W2L_G:
    s_sub_u32 s7, s7, 1
    s_cbranch_scc1 W2L_G_X
    buffer_load_dword v42, v40, s[92:95], 0 offen sc1
    s_waitcnt vmcnt(0)
    v_cmp_ne_u32 vcc, 0, v42
    s_cmp_eq_u64 vcc, -1
    s_cbranch_scc0 W2L_G
    s_branch W2L_G_X
W2_DEQ:
    s_mov_b32 s38, s4
    s_add_u32 s4, s42, s38
    s_cmp_ge_u32 s4, 40
    s_cbranch_scc1 W2D_IDLE
    s_mul_i32 s43, s4, 98304
    s_mul_i32 s6, s58, 3072
    s_add_u32 s43, s43, s6
    s_lshr_b32 s6, s4, 1
    s_lshr_b32 s5, s42, 1
    s_sub_u32 s6, s6, s5
    s_mul_i32 s6, s6, 3072
    s_add_u32 s6, s6, 81920
    s_mov_b32 s10, 3932160
    v_lshrrev_b32 v2, 5, v1
    v_and_b32 v3, 31, v1
    v_lshlrev_b32 v4, 4, v3
    v_mul_u32_u24 v6, 0x1800, v2
    v_add_u32 v6, v6, v4
    v_add_u32 v22, s6, v4
    s_mul_i32 s57, s57, 3
    s_add_u32 s4, s57, 7
    s_and_b32 s4, s4, 7
    s_mul_i32 s4, s4, 12288
    v_add_u32 v13, s4, v6
    s_add_u32 s4, s57, 6
    s_and_b32 s4, s4, 7
    s_mul_i32 s4, s4, 12288
    v_add_u32 v12, s4, v6
    s_add_u32 s4, s57, 5
    s_and_b32 s4, s4, 7
    s_mul_i32 s4, s4, 12288
    v_add_u32 v11, s4, v6
    s_add_u32 s4, s57, 4
    s_and_b32 s4, s4, 7
    s_mul_i32 s4, s4, 12288
    v_add_u32 v10, s4, v6
    s_add_u32 s4, s57, 3
    s_and_b32 s4, s4, 7
    s_mul_i32 s4, s4, 12288
    v_add_u32 v9, s4, v6
    s_add_u32 s4, s57, 2
    s_and_b32 s4, s4, 7
    s_mul_i32 s4, s4, 12288
    v_add_u32 v8, s4, v6
    s_add_u32 s4, s57, 1
    s_and_b32 s4, s4, 7
    s_mul_i32 s4, s4, 12288
    v_add_u32 v7, s4, v6
    s_add_u32 s4, s57, 0
    s_and_b32 s4, s4, 7
    s_mul_i32 s4, s4, 12288
    v_add_u32 v6, s4, v6
    s_waitcnt lgkmcnt(0)
    buffer_load_dwordx4 v[52:55], v6, s[8:11], s43 offen offset:0
    buffer_load_dwordx4 v[56:59], v7, s[8:11], s43 offen offset:0
    buffer_load_dwordx4 v[60:63], v8, s[8:11], s43 offen offset:0
    buffer_load_dwordx4 v[64:67], v9, s[8:11], s43 offen offset:0
    buffer_load_dwordx4 v[68:71], v10, s[8:11], s43 offen offset:0
    buffer_load_dwordx4 v[72:75], v11, s[8:11], s43 offen offset:0
    buffer_load_dwordx4 v[76:79], v12, s[8:11], s43 offen offset:0
    buffer_load_dwordx4 v[80:83], v13, s[8:11], s43 offen offset:0
    buffer_load_dwordx4 v[84:87], v6, s[8:11], s43 offen offset:512
    buffer_load_dwordx4 v[88:91], v7, s[8:11], s43 offen offset:512
    buffer_load_dwordx4 v[92:95], v8, s[8:11], s43 offen offset:512
    buffer_load_dwordx4 v[96:99], v9, s[8:11], s43 offen offset:512
    s_add_u32 s43, s43, 512
    s_lshl_b32 s4, s38, 12
    s_add_u32 s4, s4, 131072
    v_bfe_u32 v3, v1, 1, 4
    v_xor_b32 v4, v3, v2
    v_lshlrev_b32 v4, 4, v4
    v_lshl_add_u32 v4, v2, 8, v4
    v_and_b32 v3, 1, v1
    v_lshl_add_u32 v4, v3, 3, v4
    v_add_u32 v14, s4, v4
    s_add_u32 s4, s57, 7
    s_and_b32 s4, s4, 7
    s_lshl_b32 s5, s4, 5
    s_lshl_b32 s4, s4, 9
    v_xor_b32 v3, s5, v14
    v_add_u32 v21, s4, v3
    s_add_u32 s4, s57, 6
    s_and_b32 s4, s4, 7
    s_lshl_b32 s5, s4, 5
    s_lshl_b32 s4, s4, 9
    v_xor_b32 v3, s5, v14
    v_add_u32 v20, s4, v3
    s_add_u32 s4, s57, 5
    s_and_b32 s4, s4, 7
    s_lshl_b32 s5, s4, 5
    s_lshl_b32 s4, s4, 9
    v_xor_b32 v3, s5, v14
    v_add_u32 v19, s4, v3
    s_add_u32 s4, s57, 4
    s_and_b32 s4, s4, 7
    s_lshl_b32 s5, s4, 5
    s_lshl_b32 s4, s4, 9
    v_xor_b32 v3, s5, v14
    v_add_u32 v18, s4, v3
    s_add_u32 s4, s57, 3
    s_and_b32 s4, s4, 7
    s_lshl_b32 s5, s4, 5
    s_lshl_b32 s4, s4, 9
    v_xor_b32 v3, s5, v14
    v_add_u32 v17, s4, v3
    s_add_u32 s4, s57, 2
    s_and_b32 s4, s4, 7
    s_lshl_b32 s5, s4, 5
    s_lshl_b32 s4, s4, 9
    v_xor_b32 v3, s5, v14
    v_add_u32 v16, s4, v3
    s_add_u32 s4, s57, 1
    s_and_b32 s4, s4, 7
    s_lshl_b32 s5, s4, 5
    s_lshl_b32 s4, s4, 9
    v_xor_b32 v3, s5, v14
    v_add_u32 v15, s4, v3
    s_add_u32 s4, s57, 0
    s_and_b32 s4, s4, 7
    s_lshl_b32 s5, s4, 5
    s_lshl_b32 s4, s4, 9
    v_xor_b32 v3, s5, v14
    v_add_u32 v14, s4, v3
    s_mov_b32 s49, 0
    s_xor_b32 s4, s41, 1
    s_mul_i32 s5, s40, 12
    s_add_u32 s4, s4, s5
    s_lshl_b32 s45, s4, 7
    s_add_u32 s45, s45, 4653056
    s_mul_i32 s46, s4, 24576
    s_mul_i32 s47, s38, 6144
    s_add_u32 s46, s46, s47
    s_add_u32 s46, s46, 4784128
    s_add_u32 s47, s47, 143360
    s_mov_b32 s48, 4294942720
    s_mov_b32 s61, 0
    s_barrier
    s_setprio 3
    ds_read_b128 v[24:27], v22
    ds_read_b128 v[28:31], v22 offset:6144
    v_add_u32 v22, 512, v22
    buffer_load_dwordx4 v[100:103], v10, s[8:11], s43 offen
    buffer_load_dwordx4 v[104:107], v11, s[8:11], s43 offen
    buffer_load_dwordx4 v[108:111], v12, s[8:11], s43 offen
    buffer_load_dwordx4 v[112:115], v13, s[8:11], s43 offen
    s_waitcnt lgkmcnt(0)
W2D_LOOP:
    ds_read_b128 v[32:35], v22
    ds_read_b128 v[36:39], v22 offset:6144
    v_add_u32 v22, 512, v22
    s_add_u32 s43, s43, 512
    s_cmp_lt_u32 s49, 10
    s_waitcnt vmcnt(8)
    s_cbranch_scc1 W2D_NT0
    s_waitcnt vmcnt(8)
W2D_NT0:
    s_cmp_lt_u32 s49, 8
    v_fma_f32 v40, v52, v24, v28
    v_fma_f32 v41, v53, v25, v29
    v_fma_f32 v42, v54, v26, v30
    v_fma_f32 v43, v55, v27, v31
    v_cvt_pk_bf16_f32 v48, v40, v41
    v_cvt_pk_bf16_f32 v49, v42, v43
    ds_write_b64 v14, v[48:49] offset:12288
    v_fma_f32 v44, v56, v24, v28
    v_fma_f32 v45, v57, v25, v29
    v_fma_f32 v46, v58, v26, v30
    v_fma_f32 v47, v59, v27, v31
    v_cvt_pk_bf16_f32 v50, v44, v45
    v_cvt_pk_bf16_f32 v51, v46, v47
    ds_write_b64 v15, v[50:51] offset:12288
    s_cbranch_scc0 W2D_SK0_1
    buffer_load_dwordx4 v[52:55], v6, s[8:11], s43 offen
    buffer_load_dwordx4 v[56:59], v7, s[8:11], s43 offen
W2D_SK0_1:
    v_fma_f32 v40, v60, v24, v28
    v_fma_f32 v41, v61, v25, v29
    v_fma_f32 v42, v62, v26, v30
    v_fma_f32 v43, v63, v27, v31
    v_cvt_pk_bf16_f32 v48, v40, v41
    v_cvt_pk_bf16_f32 v49, v42, v43
    ds_write_b64 v16, v[48:49] offset:12288
    v_fma_f32 v44, v64, v24, v28
    v_fma_f32 v45, v65, v25, v29
    v_fma_f32 v46, v66, v26, v30
    v_fma_f32 v47, v67, v27, v31
    v_cvt_pk_bf16_f32 v50, v44, v45
    v_cvt_pk_bf16_f32 v51, v46, v47
    ds_write_b64 v17, v[50:51] offset:12288
    s_cbranch_scc0 W2D_SK0_3
    buffer_load_dwordx4 v[60:63], v8, s[8:11], s43 offen
    buffer_load_dwordx4 v[64:67], v9, s[8:11], s43 offen
W2D_SK0_3:
    s_cmp_eq_u32 s49, 0
    s_cbranch_scc1 W2D_NM
    s_barrier
    s_cmp_lt_u32 s49, 8
W2D_NM:
    v_fma_f32 v40, v68, v24, v28
    v_fma_f32 v41, v69, v25, v29
    v_fma_f32 v42, v70, v26, v30
    v_fma_f32 v43, v71, v27, v31
    v_cvt_pk_bf16_f32 v48, v40, v41
    v_cvt_pk_bf16_f32 v49, v42, v43
    ds_write_b64 v18, v[48:49] offset:12288
    v_fma_f32 v44, v72, v24, v28
    v_fma_f32 v45, v73, v25, v29
    v_fma_f32 v46, v74, v26, v30
    v_fma_f32 v47, v75, v27, v31
    v_cvt_pk_bf16_f32 v50, v44, v45
    v_cvt_pk_bf16_f32 v51, v46, v47
    ds_write_b64 v19, v[50:51] offset:12288
    s_cbranch_scc0 W2D_SK0_5
    buffer_load_dwordx4 v[68:71], v10, s[8:11], s43 offen
    buffer_load_dwordx4 v[72:75], v11, s[8:11], s43 offen
W2D_SK0_5:
    v_fma_f32 v40, v76, v24, v28
    v_fma_f32 v41, v77, v25, v29
    v_fma_f32 v42, v78, v26, v30
    v_fma_f32 v43, v79, v27, v31
    v_cvt_pk_bf16_f32 v48, v40, v41
    v_cvt_pk_bf16_f32 v49, v42, v43
    ds_write_b64 v20, v[48:49] offset:12288
    v_fma_f32 v44, v80, v24, v28
    v_fma_f32 v45, v81, v25, v29
    v_fma_f32 v46, v82, v26, v30
    v_fma_f32 v47, v83, v27, v31
    v_cvt_pk_bf16_f32 v50, v44, v45
    v_cvt_pk_bf16_f32 v51, v46, v47
    ds_write_b64 v21, v[50:51] offset:12288
    s_cbranch_scc0 W2D_SK0_7
    buffer_load_dwordx4 v[76:79], v12, s[8:11], s43 offen
    buffer_load_dwordx4 v[80:83], v13, s[8:11], s43 offen
W2D_SK0_7:
    s_waitcnt lgkmcnt(0)
    s_barrier
    ds_read_b128 v[24:27], v22
    ds_read_b128 v[28:31], v22 offset:6144
    v_add_u32 v22, 512, v22
    s_add_u32 s43, s43, 512
    s_cmp_lt_u32 s49, 8
    s_waitcnt vmcnt(8)
    s_cbranch_scc1 W2D_NT1
    s_waitcnt vmcnt(0)
W2D_NT1:
    s_cmp_lt_u32 s49, 6
    v_fma_f32 v40, v84, v32, v36
    v_fma_f32 v41, v85, v33, v37
    v_fma_f32 v42, v86, v34, v38
    v_fma_f32 v43, v87, v35, v39
    v_cvt_pk_bf16_f32 v48, v40, v41
    v_cvt_pk_bf16_f32 v49, v42, v43
    ds_write_b64 v14, v[48:49] offset:0
    v_fma_f32 v44, v88, v32, v36
    v_fma_f32 v45, v89, v33, v37
    v_fma_f32 v46, v90, v34, v38
    v_fma_f32 v47, v91, v35, v39
    v_cvt_pk_bf16_f32 v50, v44, v45
    v_cvt_pk_bf16_f32 v51, v46, v47
    ds_write_b64 v15, v[50:51] offset:0
    v_add_u32 v14, s48, v14
    s_cbranch_scc0 W2D_SK1_1
    buffer_load_dwordx4 v[84:87], v6, s[8:11], s43 offen
    buffer_load_dwordx4 v[88:91], v7, s[8:11], s43 offen
W2D_SK1_1:
    v_fma_f32 v40, v92, v32, v36
    v_fma_f32 v41, v93, v33, v37
    v_fma_f32 v42, v94, v34, v38
    v_fma_f32 v43, v95, v35, v39
    v_cvt_pk_bf16_f32 v48, v40, v41
    v_cvt_pk_bf16_f32 v49, v42, v43
    ds_write_b64 v16, v[48:49] offset:0
    v_add_u32 v15, s48, v15
    v_fma_f32 v44, v96, v32, v36
    v_fma_f32 v45, v97, v33, v37
    v_fma_f32 v46, v98, v34, v38
    v_fma_f32 v47, v99, v35, v39
    v_cvt_pk_bf16_f32 v50, v44, v45
    v_cvt_pk_bf16_f32 v51, v46, v47
    ds_write_b64 v17, v[50:51] offset:0
    v_add_u32 v16, s48, v16
    s_cbranch_scc0 W2D_SK1_3
    buffer_load_dwordx4 v[92:95], v8, s[8:11], s43 offen
    buffer_load_dwordx4 v[96:99], v9, s[8:11], s43 offen
W2D_SK1_3:
    s_barrier
    v_fma_f32 v40, v100, v32, v36
    v_fma_f32 v41, v101, v33, v37
    v_fma_f32 v42, v102, v34, v38
    v_fma_f32 v43, v103, v35, v39
    v_cvt_pk_bf16_f32 v48, v40, v41
    v_cvt_pk_bf16_f32 v49, v42, v43
    ds_write_b64 v18, v[48:49] offset:0
    v_add_u32 v17, s48, v17
    v_fma_f32 v44, v104, v32, v36
    v_fma_f32 v45, v105, v33, v37
    v_fma_f32 v46, v106, v34, v38
    v_fma_f32 v47, v107, v35, v39
    v_cvt_pk_bf16_f32 v50, v44, v45
    v_cvt_pk_bf16_f32 v51, v46, v47
    ds_write_b64 v19, v[50:51] offset:0
    v_add_u32 v18, s48, v18
    s_cbranch_scc0 W2D_SK1_5
    buffer_load_dwordx4 v[100:103], v10, s[8:11], s43 offen
    buffer_load_dwordx4 v[104:107], v11, s[8:11], s43 offen
W2D_SK1_5:
    v_fma_f32 v40, v108, v32, v36
    v_fma_f32 v41, v109, v33, v37
    v_fma_f32 v42, v110, v34, v38
    v_fma_f32 v43, v111, v35, v39
    v_cvt_pk_bf16_f32 v48, v40, v41
    v_cvt_pk_bf16_f32 v49, v42, v43
    ds_write_b64 v20, v[48:49] offset:0
    v_add_u32 v19, s48, v19
    v_fma_f32 v44, v112, v32, v36
    v_fma_f32 v45, v113, v33, v37
    v_fma_f32 v46, v114, v34, v38
    v_fma_f32 v47, v115, v35, v39
    v_cvt_pk_bf16_f32 v50, v44, v45
    v_cvt_pk_bf16_f32 v51, v46, v47
    ds_write_b64 v21, v[50:51] offset:0
    v_add_u32 v20, s48, v20
    s_cbranch_scc0 W2D_SK1_7
    buffer_load_dwordx4 v[108:111], v12, s[8:11], s43 offen
    buffer_load_dwordx4 v[112:115], v13, s[8:11], s43 offen
W2D_SK1_7:
    v_add_u32 v21, s48, v21
    s_waitcnt lgkmcnt(0)
    s_barrier
    s_add_u32 s49, s49, 4
    s_cmp_lt_u32 s49, 12
    s_cbranch_scc1 W2D_LOOP
    s_cmp_eq_u32 s38, 2
    s_cbranch_scc1 W2D_H
    s_setprio 0
    s_mov_b32 m0, s47
    s_barrier
    s_barrier
    s_buffer_load_dword s61, s[24:27], s45 glc
    s_barrier
    s_buffer_load_dword s61, s[24:27], s45 glc
    s_barrier
    s_mov_b32 s49, 15
W2D_PL:
    s_cmp_ge_u32 s61, 4
    s_cbranch_scc1 W2D_GOT
    s_buffer_load_dword s61, s[24:27], s45 glc
    s_barrier
    s_add_u32 s49, s49, 1
    s_cmp_lt_u32 s49, 24
    s_cbranch_scc1 W2D_PL
    s_mov_b32 s7, 40000
    s_branch W2D_P_C
W2D_P:
    s_sub_u32 s7, s7, 1
    s_cbranch_scc1 W2D_P_X
    s_buffer_load_dword s61, s[24:27], s45 glc
W2D_P_C:
    s_waitcnt lgkmcnt(0)
    s_cmp_lt_u32 s61, 4
    s_cbranch_scc1 W2D_P
W2D_P_X:
W2D_GOT:
    buffer_load_dwordx4 v5, s[24:27], s46 offen offset:0 sc1 lds
    buffer_load_dwordx4 v5, s[24:27], s46 offen offset:1024 sc1 lds
    buffer_load_dwordx4 v5, s[24:27], s46 offen offset:2048 sc1 lds
    buffer_load_dwordx4 v5, s[24:27], s46 offen offset:3072 sc1 lds
    s_add_u32 m0, m0, 4096
    s_add_u32 s46, s46, 4096
    buffer_load_dwordx4 v5, s[24:27], s46 offen offset:0 sc1 lds
    buffer_load_dwordx4 v5, s[24:27], s46 offen offset:1024 sc1 lds
    s_and_b32 s38, s37, 3
    s_lshl_b32 s38, s38, 2
    s_and_b32 s39, s3, 3
    s_add_u32 s38, s38, s39
    s_lshr_b32 s39, s37, 2
    s_lshl_b32 s39, s39, 3
    s_lshr_b32 s4, s3, 2
    s_add_u32 s39, s39, s4
    s_lshl_b32 s45, s38, 4
    s_add_u32 s45, s45, s39
    s_lshl_b32 s45, s45, 7
    s_add_u32 s44, s45, 4620288
    s_add_u32 s45, s45, 4587520
    s_max_u32 s4, s36, 5
    s_mul_i32 s4, s4, 32
    s_add_u32 s44, s44, s4
    s_sub_u32 s44, s44, 160
    s_branch W2D_R1
W2D_R0:
    s_barrier
    s_add_u32 s49, s49, 1
W2D_R1:
    s_cmp_lt_u32 s49, 24
    s_cbranch_scc1 W2D_R0
    s_buffer_load_dword s62, s[24:27], s44 glc
    s_waitcnt vmcnt(0)
    s_barrier
    s_branch P2_MM
W2D_IDLE:
    s_mov_b32 s49, 0
    s_waitcnt lgkmcnt(0)
    s_cmp_eq_u32 s38, 2
    s_cselect_b32 s49, 14, 0
W2D_IDL:
    s_barrier
    s_add_u32 s49, s49, 1
    s_cmp_lt_u32 s49, 26
    s_cbranch_scc1 W2D_IDL
    s_cmp_lg_u32 s38, 2
    s_cbranch_scc1 P2_MM
    s_setprio 3
W2D_H:
    s_mov_b32 s14, 4718592
    v_lshrrev_b32 v2, 4, v1
    v_and_b32 v3, 15, v1
    v_lshlrev_b32 v4, 1, v2
    v_xor_b32 v3, v3, v4
    v_lshlrev_b32 v3, 4, v3
    v_mul_u32_u24 v4, 0xc00, v2
    v_add_u32 v6, v3, v4
    v_add_u32 v7, 11264, v6
    v_xor_b32 v3, 0x80, v6
    v_add_u32 v8, 22528, v3
    v_add_u32 v9, 33792, v3
    v_add_u32 v10, 49152, v6
    v_add_u32 v11, 49152, v7
    v_add_u32 v12, 49152, v8
    v_add_u32 v13, 49152, v9
    s_xor_b32 s43, s41, 1
    s_lshl_b32 s43, s43, 8
    s_mul_i32 s4, s58, 2359296
    s_add_u32 s43, s43, s4
    s_add_u32 s43, s43, 688128
    s_movk_i32 s47, 8192
    s_mov_b32 m0, 8192
    s_mov_b32 s49, 15
    s_barrier
    s_branch W2L2
W2_MFMA:
    s_lshl_b32 s4, s36, 13
    s_mov_b32 m0, s4
    s_mul_i32 s4, s36, 98304
    s_add_u32 s43, s43, s4
    s_lshr_b32 s6, s42, 1
    s_lshl1_add_u32 s6, s6, s58
    s_mul_i32 s6, s6, 1536
    s_mov_b32 s18, 61440
    s_mov_b32 s19, 0x00020000
    s_mov_b32 s22, 61440
    s_mov_b32 s23, 0x00020000
    s_min_u32 s5, s36, 2
    s_lshl_b32 s5, s5, 9
    v_lshl_add_u32 v23, v1, 3, s5
    s_waitcnt lgkmcnt(0)
    buffer_load_dwordx2 v[72:73], v23, s[16:19], s6 offen offset:0
    buffer_load_dwordx2 v[74:75], v23, s[20:23], s6 offen offset:0
    buffer_load_dwordx2 v[76:77], v23, s[16:19], s6 offen offset:3072
    buffer_load_dwordx2 v[78:79], v23, s[20:23], s6 offen offset:3072
    buffer_load_dwordx4 v6, s[12:15], s43 offen offset:0 lds
    buffer_load_dwordx4 v7, s[12:15], s43 offen offset:1024 lds
    buffer_load_dwordx4 v8, s[12:15], s43 offen offset:2048 lds
    buffer_load_dwordx4 v9, s[12:15], s43 offen offset:3072 lds
    s_add_u32 m0, m0, 4096
    s_add_u32 s43, s43, 49152
    buffer_load_dwordx4 v6, s[12:15], s43 offen offset:0 lds
    buffer_load_dwordx4 v7, s[12:15], s43 offen offset:1024 lds
    buffer_load_dwordx4 v8, s[12:15], s43 offen offset:2048 lds
    buffer_load_dwordx4 v9, s[12:15], s43 offen offset:3072 lds
    v_lshlrev_b32 v23, 1, v23
    v_add_u32 v23, 81920, v23
    v_and_b32 v2, 15, v1
    v_lshrrev_b32 v3, 4, v1
    v_xor_b32 v4, v2, v3
    v_lshlrev_b32 v4, 4, v4
    v_lshl_add_u32 v4, v2, 8, v4
    v_add_u32 v10, 81920, v4
    v_xor_b32 v11, 64, v10
    v_xor_b32 v12, 128, v10
    v_xor_b32 v13, 192, v10
    v_add_u32 v14, 36864, v10
    v_add_u32 v15, 36864, v11
    v_add_u32 v16, 36864, v12
    v_add_u32 v17, 36864, v13
    v_bfe_u32 v2, v1, 2, 2
    v_and_b32 v4, 1, v3
    v_lshl_or_b32 v4, v4, 2, v2
    s_lshl_b32 s5, s36, 1
    v_xor_b32 v4, s5, v4
    v_lshlrev_b32 v4, 5, v4
    v_lshl_add_u32 v2, v3, 3, v2
    v_lshl_add_u32 v4, v2, 8, v4
    v_and_b32 v2, 3, v1
    v_lshl_add_u32 v18, v2, 3, v4
    v_xor_b32 v19, 32, v18
    v_add_u32 v20, 40960, v18
    v_add_u32 v21, 40960, v19
    s_mul_i32 s4, s40, 12
    s_add_u32 s4, s4, s41
    s_lshl_b32 s45, s4, 7
    s_add_u32 s45, s45, 4653056
    s_mul_i32 s44, s4, 24576
    s_lshl_b32 s5, s36, 10
    s_add_u32 s44, s44, s5
    s_add_u32 s44, s44, 4784128
    s_add_u32 s5, s5, 143360
    v_add_u32 v6, s5, v5
    s_xor_b32 s41, s41, 1
    s_lshl_b32 s4, s41, 2
    s_add_u32 s4, s4, s36
    s_mul_i32 s5, s4, 40
    s_add_u32 s5, s5, s42
    s_lshl_b32 s5, s5, 10
    s_add_u32 s50, s5, 2621440
    s_mul_i32 s51, s4, 171
    s_lshr_b32 s51, s51, 9
    s_lshl_b32 s51, s51, 7
    s_add_u32 s51, s51, 4587520
    s_mov_b32 s53, 11
    s_mov_b32 s54, 0x52000000
    s_mov_b32 s55, 0x52000000
    s_mov_b32 s46, 0xffff0000
    s_mov_b32 s47, 0x77800000
    s_mov_b32 s48, 0xad000000
    v_bfe_u32 v3, v1, 4, 1
    v_lshrrev_b32 v4, 5, v1
    v_and_b32 v22, 15, v1
    v_lshl_add_u32 v22, v3, 5, v22
    v_lshl_add_u32 v22, v4, 4, v22
    v_lshlrev_b32 v22, 4, v22
    v_mov_b32 v7, 1
    v_mov_b32 v8, 0
    s_waitcnt vmcnt(10)
    v_lshlrev_b32 v88, 16, v72
    v_and_b32 v89, s46, v72
    v_lshlrev_b32 v90, 16, v73
    v_and_b32 v91, s46, v73
    v_lshlrev_b32 v92, 16, v74
    v_and_b32 v93, s46, v74
    v_lshlrev_b32 v94, 16, v75
    v_and_b32 v95, s46, v75
    v_mul_f32 v92, s48, v92
    v_mul_f32 v93, s48, v93
    v_mul_f32 v94, s48, v94
    v_mul_f32 v95, s48, v95
    v_mul_f32 v92, v88, v92
    v_mul_f32 v93, v89, v93
    v_mul_f32 v94, v90, v94
    v_mul_f32 v95, v91, v95
    v_mul_f32 v88, s47, v88
    v_mul_f32 v89, s47, v89
    v_mul_f32 v90, s47, v90
    v_mul_f32 v91, s47, v91
    ds_write_b128 v23, v[88:91] offset:0
    ds_write_b128 v23, v[92:95] offset:6144
    s_waitcnt vmcnt(8)
    v_lshlrev_b32 v96, 16, v76
    v_and_b32 v97, s46, v76
    v_lshlrev_b32 v98, 16, v77
    v_and_b32 v99, s46, v77
    v_lshlrev_b32 v100, 16, v78
    v_and_b32 v101, s46, v78
    v_lshlrev_b32 v102, 16, v79
    v_and_b32 v103, s46, v79
    v_mul_f32 v100, s48, v100
    v_mul_f32 v101, s48, v101
    v_mul_f32 v102, s48, v102
    v_mul_f32 v103, s48, v103
    v_mul_f32 v100, v96, v100
    v_mul_f32 v101, v97, v101
    v_mul_f32 v102, v98, v102
    v_mul_f32 v103, v99, v103
    v_mul_f32 v96, s47, v96
    v_mul_f32 v97, s47, v97
    v_mul_f32 v98, s47, v98
    v_mul_f32 v99, s47, v99
    ds_write_b128 v23, v[96:99] offset:3072
    ds_write_b128 v23, v[100:103] offset:9216
    s_waitcnt lgkmcnt(0)
    s_barrier
    s_waitcnt vmcnt(0)
    s_mov_b32 s56, 0x5200
    s_mov_b32 s57, 0x52000000
    s_barrier
    ds_read_b128 v[72:75], v14 offset:24576
    ds_read_b128 v[76:79], v14 offset:28672
    ds_read_b128 v[80:83], v14 offset:32768
    ds_read_b64_tr_b16 v[84:85], v18 offset:0
    ds_read_b64_tr_b16 v[86:87], v18 offset:1024
    ds_read_b64_tr_b16 v[88:89], v19 offset:0
    ds_read_b64_tr_b16 v[90:91], v19 offset:1024
    ds_read_b128 v[92:95], v15 offset:24576
    ds_read_b128 v[96:99], v15 offset:28672
    ds_read_b128 v[100:103], v15 offset:32768
    ds_read_b64_tr_b16 v[104:105], v18 offset:8192
    ds_read_b64_tr_b16 v[106:107], v18 offset:9216
    ds_read_b64_tr_b16 v[108:109], v19 offset:8192
    ds_read_b64_tr_b16 v[110:111], v19 offset:9216
    s_waitcnt lgkmcnt(9)
    v_mfma_f32_16x16x32_bf16 v[24:27], v[72:75], v[84:87], 0
    s_waitcnt lgkmcnt(7)
    v_mfma_f32_16x16x32_bf16 v[28:31], v[72:75], v[88:91], 0
    v_mfma_f32_16x16x32_bf16 v[32:35], v[76:79], v[84:87], 0
    v_mfma_f32_16x16x32_bf16 v[36:39], v[76:79], v[88:91], 0
    v_mfma_f32_16x16x32_bf16 v[40:43], v[80:83], v[84:87], 0
    v_mfma_f32_16x16x32_bf16 v[44:47], v[80:83], v[88:91], 0
    s_waitcnt lgkmcnt(0)
    s_barrier
    ds_read_b128 v[112:115], v16 offset:24576
    ds_read_b128 v[116:119], v16 offset:28672
    v_mfma_f32_16x16x32_bf16 v[24:27], v[92:95], v[104:107], v[24:27]
    ds_read_b128 v[120:123], v16 offset:32768
    ds_read_b64_tr_b16 v[124:125], v18 offset:16384
    v_mfma_f32_16x16x32_bf16 v[28:31], v[92:95], v[108:111], v[28:31]
    ds_read_b64_tr_b16 v[126:127], v18 offset:17408
    ds_read_b64_tr_b16 v[128:129], v19 offset:16384
    v_mfma_f32_16x16x32_bf16 v[32:35], v[96:99], v[104:107], v[32:35]
    ds_read_b64_tr_b16 v[130:131], v19 offset:17408
    ds_read_b128 v[132:135], v17 offset:24576
    v_mfma_f32_16x16x32_bf16 v[36:39], v[96:99], v[108:111], v[36:39]
    ds_read_b128 v[136:139], v17 offset:28672
    ds_read_b128 v[140:143], v17 offset:32768
    v_mfma_f32_16x16x32_bf16 v[40:43], v[100:103], v[104:107], v[40:43]
    ds_read_b64_tr_b16 v[144:145], v18 offset:24576
    ds_read_b64_tr_b16 v[146:147], v18 offset:25600
    v_mfma_f32_16x16x32_bf16 v[44:47], v[100:103], v[108:111], v[44:47]
    ds_read_b64_tr_b16 v[148:149], v19 offset:24576
    ds_read_b64_tr_b16 v[150:151], v19 offset:25600
    s_waitcnt lgkmcnt(9)
    v_mfma_f32_16x16x32_bf16 v[24:27], v[112:115], v[124:127], v[24:27]
    s_waitcnt lgkmcnt(7)
    v_mfma_f32_16x16x32_bf16 v[28:31], v[112:115], v[128:131], v[28:31]
    v_mfma_f32_16x16x32_bf16 v[32:35], v[116:119], v[124:127], v[32:35]
    v_mfma_f32_16x16x32_bf16 v[36:39], v[116:119], v[128:131], v[36:39]
    v_mfma_f32_16x16x32_bf16 v[40:43], v[120:123], v[124:127], v[40:43]
    v_mfma_f32_16x16x32_bf16 v[44:47], v[120:123], v[128:131], v[44:47]
    s_waitcnt lgkmcnt(0)
    s_barrier
    ds_read_b128 v[72:75], v14 offset:12288
    ds_read_b128 v[76:79], v14 offset:16384
    v_mfma_f32_16x16x32_bf16 v[24:27], v[132:135], v[144:147], v[24:27]
    ds_read_b128 v[80:83], v14 offset:20480
    ds_read_b64_tr_b16 v[84:85], v18 offset:32768
    v_mfma_f32_16x16x32_bf16 v[28:31], v[132:135], v[148:151], v[28:31]
    ds_read_b64_tr_b16 v[86:87], v18 offset:33792
    ds_read_b64_tr_b16 v[88:89], v19 offset:32768
    v_mfma_f32_16x16x32_bf16 v[32:35], v[136:139], v[144:147], v[32:35]
    ds_read_b64_tr_b16 v[90:91], v19 offset:33792
    ds_read_b128 v[92:95], v15 offset:12288
    v_mfma_f32_16x16x32_bf16 v[36:39], v[136:139], v[148:151], v[36:39]
    ds_read_b128 v[96:99], v15 offset:16384
    ds_read_b128 v[100:103], v15 offset:20480
    v_mfma_f32_16x16x32_bf16 v[40:43], v[140:143], v[144:147], v[40:43]
    ds_read_b64_tr_b16 v[104:105], v20 offset:0
    ds_read_b64_tr_b16 v[106:107], v20 offset:1024
    v_mfma_f32_16x16x32_bf16 v[44:47], v[140:143], v[148:151], v[44:47]
    ds_read_b64_tr_b16 v[108:109], v21 offset:0
    ds_read_b64_tr_b16 v[110:111], v21 offset:1024
    s_waitcnt lgkmcnt(9)
    v_mfma_f32_16x16x32_bf16 v[24:27], v[72:75], v[84:87], v[24:27]
    s_waitcnt lgkmcnt(7)
    v_mfma_f32_16x16x32_bf16 v[28:31], v[72:75], v[88:91], v[28:31]
    v_mfma_f32_16x16x32_bf16 v[32:35], v[76:79], v[84:87], v[32:35]
    v_mfma_f32_16x16x32_bf16 v[36:39], v[76:79], v[88:91], v[36:39]
    v_mfma_f32_16x16x32_bf16 v[40:43], v[80:83], v[84:87], v[40:43]
    v_mfma_f32_16x16x32_bf16 v[44:47], v[80:83], v[88:91], v[44:47]
    s_waitcnt lgkmcnt(0)
    s_barrier
    ds_read_b128 v[112:115], v16 offset:12288
    ds_read_b128 v[116:119], v16 offset:16384
    v_mfma_f32_16x16x32_bf16 v[24:27], v[92:95], v[104:107], v[24:27]
    ds_read_b128 v[120:123], v16 offset:20480
    ds_read_b64_tr_b16 v[124:125], v20 offset:8192
    v_mfma_f32_16x16x32_bf16 v[28:31], v[92:95], v[108:111], v[28:31]
    ds_read_b64_tr_b16 v[126:127], v20 offset:9216
    ds_read_b64_tr_b16 v[128:129], v21 offset:8192
    v_mfma_f32_16x16x32_bf16 v[32:35], v[96:99], v[104:107], v[32:35]
    ds_read_b64_tr_b16 v[130:131], v21 offset:9216
    ds_read_b128 v[132:135], v17 offset:12288
    v_mfma_f32_16x16x32_bf16 v[36:39], v[96:99], v[108:111], v[36:39]
    ds_read_b128 v[136:139], v17 offset:16384
    ds_read_b128 v[140:143], v17 offset:20480
    v_mfma_f32_16x16x32_bf16 v[40:43], v[100:103], v[104:107], v[40:43]
    ds_read_b64_tr_b16 v[144:145], v20 offset:16384
    ds_read_b64_tr_b16 v[146:147], v20 offset:17408
    v_mfma_f32_16x16x32_bf16 v[44:47], v[100:103], v[108:111], v[44:47]
    ds_read_b64_tr_b16 v[148:149], v21 offset:16384
    ds_read_b64_tr_b16 v[150:151], v21 offset:17408
    s_waitcnt lgkmcnt(9)
    v_mfma_f32_16x16x32_bf16 v[24:27], v[112:115], v[124:127], v[24:27]
    s_waitcnt lgkmcnt(7)
    v_mfma_f32_16x16x32_bf16 v[28:31], v[112:115], v[128:131], v[28:31]
    v_mfma_f32_16x16x32_bf16 v[32:35], v[116:119], v[124:127], v[32:35]
    v_mfma_f32_16x16x32_bf16 v[36:39], v[116:119], v[128:131], v[36:39]
    v_mfma_f32_16x16x32_bf16 v[40:43], v[120:123], v[124:127], v[40:43]
    v_mfma_f32_16x16x32_bf16 v[44:47], v[120:123], v[128:131], v[44:47]
    s_waitcnt lgkmcnt(0)
    s_barrier
    ds_read_b128 v[72:75], v14 offset:0
    ds_read_b128 v[76:79], v14 offset:4096
    v_mfma_f32_16x16x32_bf16 v[24:27], v[132:135], v[144:147], v[24:27]
    ds_read_b128 v[80:83], v14 offset:8192
    ds_read_b64_tr_b16 v[84:85], v20 offset:24576
    v_mfma_f32_16x16x32_bf16 v[28:31], v[132:135], v[148:151], v[28:31]
    ds_read_b64_tr_b16 v[86:87], v20 offset:25600
    ds_read_b64_tr_b16 v[88:89], v21 offset:24576
    v_mfma_f32_16x16x32_bf16 v[32:35], v[136:139], v[144:147], v[32:35]
    ds_read_b64_tr_b16 v[90:91], v21 offset:25600
    ds_read_b128 v[92:95], v15 offset:0
    v_mfma_f32_16x16x32_bf16 v[36:39], v[136:139], v[148:151], v[36:39]
    ds_read_b128 v[96:99], v15 offset:4096
    ds_read_b128 v[100:103], v15 offset:8192
    v_mfma_f32_16x16x32_bf16 v[40:43], v[140:143], v[144:147], v[40:43]
    ds_read_b64_tr_b16 v[104:105], v20 offset:32768
    ds_read_b64_tr_b16 v[106:107], v20 offset:33792
    v_mfma_f32_16x16x32_bf16 v[44:47], v[140:143], v[148:151], v[44:47]
    ds_read_b64_tr_b16 v[108:109], v21 offset:32768
    ds_read_b64_tr_b16 v[110:111], v21 offset:33792
    s_waitcnt lgkmcnt(9)
    v_mfma_f32_16x16x32_bf16 v[24:27], v[72:75], v[84:87], v[24:27]
    s_waitcnt lgkmcnt(7)
    v_mfma_f32_16x16x32_bf16 v[28:31], v[72:75], v[88:91], v[28:31]
    v_mfma_f32_16x16x32_bf16 v[32:35], v[76:79], v[84:87], v[32:35]
    v_mfma_f32_16x16x32_bf16 v[36:39], v[76:79], v[88:91], v[36:39]
    v_mfma_f32_16x16x32_bf16 v[40:43], v[80:83], v[84:87], v[40:43]
    v_mfma_f32_16x16x32_bf16 v[44:47], v[80:83], v[88:91], v[44:47]
    s_waitcnt lgkmcnt(0)
    s_barrier
    ds_read_b128 v[112:115], v16 offset:0
    ds_read_b128 v[116:119], v16 offset:4096
    v_mfma_f32_16x16x32_bf16 v[24:27], v[92:95], v[104:107], v[24:27]
    ds_read_b128 v[120:123], v16 offset:8192
    ds_read_b64_tr_b16 v[124:125], v18 offset:0
    v_mfma_f32_16x16x32_bf16 v[28:31], v[92:95], v[108:111], v[28:31]
    ds_read_b64_tr_b16 v[126:127], v18 offset:1024
    ds_read_b64_tr_b16 v[128:129], v19 offset:0
    v_mfma_f32_16x16x32_bf16 v[32:35], v[96:99], v[104:107], v[32:35]
    ds_read_b64_tr_b16 v[130:131], v19 offset:1024
    ds_read_b128 v[132:135], v17 offset:0
    v_mfma_f32_16x16x32_bf16 v[36:39], v[96:99], v[108:111], v[36:39]
    ds_read_b128 v[136:139], v17 offset:4096
    ds_read_b128 v[140:143], v17 offset:8192
    v_mfma_f32_16x16x32_bf16 v[40:43], v[100:103], v[104:107], v[40:43]
    ds_read_b64_tr_b16 v[144:145], v18 offset:8192
    ds_read_b64_tr_b16 v[146:147], v18 offset:9216
    v_mfma_f32_16x16x32_bf16 v[44:47], v[100:103], v[108:111], v[44:47]
    ds_read_b64_tr_b16 v[148:149], v19 offset:8192
    ds_read_b64_tr_b16 v[150:151], v19 offset:9216
    s_waitcnt lgkmcnt(9)
    v_mfma_f32_16x16x32_bf16 v[24:27], v[112:115], v[124:127], v[24:27]
    s_waitcnt lgkmcnt(7)
    v_mfma_f32_16x16x32_bf16 v[28:31], v[112:115], v[128:131], v[28:31]
    v_mfma_f32_16x16x32_bf16 v[32:35], v[116:119], v[124:127], v[32:35]
    v_mfma_f32_16x16x32_bf16 v[36:39], v[116:119], v[128:131], v[36:39]
    v_mfma_f32_16x16x32_bf16 v[40:43], v[120:123], v[124:127], v[40:43]
    v_mfma_f32_16x16x32_bf16 v[44:47], v[120:123], v[128:131], v[44:47]
    s_waitcnt lgkmcnt(0)
    s_barrier
    ds_read_b128 v[72:75], v10 offset:24576
    ds_read_b128 v[76:79], v10 offset:28672
    v_mfma_f32_16x16x32_bf16 v[24:27], v[132:135], v[144:147], v[24:27]
    ds_read_b128 v[80:83], v10 offset:32768
    ds_read_b64_tr_b16 v[84:85], v18 offset:16384
    v_mfma_f32_16x16x32_bf16 v[28:31], v[132:135], v[148:151], v[28:31]
    ds_read_b64_tr_b16 v[86:87], v18 offset:17408
    ds_read_b64_tr_b16 v[88:89], v19 offset:16384
    v_mfma_f32_16x16x32_bf16 v[32:35], v[136:139], v[144:147], v[32:35]
    ds_read_b64_tr_b16 v[90:91], v19 offset:17408
    ds_read_b128 v[92:95], v11 offset:24576
    v_mfma_f32_16x16x32_bf16 v[36:39], v[136:139], v[148:151], v[36:39]
    ds_read_b128 v[96:99], v11 offset:28672
    ds_read_b128 v[100:103], v11 offset:32768
    v_mfma_f32_16x16x32_bf16 v[40:43], v[140:143], v[144:147], v[40:43]
    ds_read_b64_tr_b16 v[104:105], v18 offset:24576
    ds_read_b64_tr_b16 v[106:107], v18 offset:25600
    v_mfma_f32_16x16x32_bf16 v[44:47], v[140:143], v[148:151], v[44:47]
    ds_read_b64_tr_b16 v[108:109], v19 offset:24576
    ds_read_b64_tr_b16 v[110:111], v19 offset:25600
    s_waitcnt lgkmcnt(9)
    v_mfma_f32_16x16x32_bf16 v[24:27], v[72:75], v[84:87], v[24:27]
    s_waitcnt lgkmcnt(7)
    v_mfma_f32_16x16x32_bf16 v[28:31], v[72:75], v[88:91], v[28:31]
    v_mfma_f32_16x16x32_bf16 v[32:35], v[76:79], v[84:87], v[32:35]
    v_mfma_f32_16x16x32_bf16 v[36:39], v[76:79], v[88:91], v[36:39]
    v_mfma_f32_16x16x32_bf16 v[40:43], v[80:83], v[84:87], v[40:43]
    v_mfma_f32_16x16x32_bf16 v[44:47], v[80:83], v[88:91], v[44:47]
    s_waitcnt lgkmcnt(0)
    s_barrier
    ds_read_b128 v[112:115], v12 offset:24576
    ds_read_b128 v[116:119], v12 offset:28672
    v_mfma_f32_16x16x32_bf16 v[24:27], v[92:95], v[104:107], v[24:27]
    ds_read_b128 v[120:123], v12 offset:32768
    ds_read_b64_tr_b16 v[124:125], v18 offset:32768
    v_mfma_f32_16x16x32_bf16 v[28:31], v[92:95], v[108:111], v[28:31]
    ds_read_b64_tr_b16 v[126:127], v18 offset:33792
    ds_read_b64_tr_b16 v[128:129], v19 offset:32768
    v_mfma_f32_16x16x32_bf16 v[32:35], v[96:99], v[104:107], v[32:35]
    ds_read_b64_tr_b16 v[130:131], v19 offset:33792
    ds_read_b128 v[132:135], v13 offset:24576
    v_mfma_f32_16x16x32_bf16 v[36:39], v[96:99], v[108:111], v[36:39]
    ds_read_b128 v[136:139], v13 offset:28672
    ds_read_b128 v[140:143], v13 offset:32768
    v_mfma_f32_16x16x32_bf16 v[40:43], v[100:103], v[104:107], v[40:43]
    ds_read_b64_tr_b16 v[144:145], v20 offset:0
    ds_read_b64_tr_b16 v[146:147], v20 offset:1024
    v_mfma_f32_16x16x32_bf16 v[44:47], v[100:103], v[108:111], v[44:47]
    ds_read_b64_tr_b16 v[148:149], v21 offset:0
    ds_read_b64_tr_b16 v[150:151], v21 offset:1024
    s_waitcnt lgkmcnt(9)
    v_mfma_f32_16x16x32_bf16 v[24:27], v[112:115], v[124:127], v[24:27]
    s_waitcnt lgkmcnt(7)
    v_mfma_f32_16x16x32_bf16 v[28:31], v[112:115], v[128:131], v[28:31]
    v_mfma_f32_16x16x32_bf16 v[32:35], v[116:119], v[124:127], v[32:35]
    v_mfma_f32_16x16x32_bf16 v[36:39], v[116:119], v[128:131], v[36:39]
    v_mfma_f32_16x16x32_bf16 v[40:43], v[120:123], v[124:127], v[40:43]
    v_mfma_f32_16x16x32_bf16 v[44:47], v[120:123], v[128:131], v[44:47]
    s_waitcnt lgkmcnt(0)
    s_barrier
    ds_read_b128 v[72:75], v10 offset:12288
    ds_read_b128 v[76:79], v10 offset:16384
    v_mfma_f32_16x16x32_bf16 v[24:27], v[132:135], v[144:147], v[24:27]
    ds_read_b128 v[80:83], v10 offset:20480
    ds_read_b64_tr_b16 v[84:85], v20 offset:8192
    v_mfma_f32_16x16x32_bf16 v[28:31], v[132:135], v[148:151], v[28:31]
    ds_read_b64_tr_b16 v[86:87], v20 offset:9216
    ds_read_b64_tr_b16 v[88:89], v21 offset:8192
    v_mfma_f32_16x16x32_bf16 v[32:35], v[136:139], v[144:147], v[32:35]
    ds_read_b64_tr_b16 v[90:91], v21 offset:9216
    ds_read_b128 v[92:95], v11 offset:12288
    v_mfma_f32_16x16x32_bf16 v[36:39], v[136:139], v[148:151], v[36:39]
    ds_read_b128 v[96:99], v11 offset:16384
    ds_read_b128 v[100:103], v11 offset:20480
    v_mfma_f32_16x16x32_bf16 v[40:43], v[140:143], v[144:147], v[40:43]
    ds_read_b64_tr_b16 v[104:105], v20 offset:16384
    ds_read_b64_tr_b16 v[106:107], v20 offset:17408
    v_mfma_f32_16x16x32_bf16 v[44:47], v[140:143], v[148:151], v[44:47]
    ds_read_b64_tr_b16 v[108:109], v21 offset:16384
    ds_read_b64_tr_b16 v[110:111], v21 offset:17408
    s_waitcnt lgkmcnt(9)
    v_mfma_f32_16x16x32_bf16 v[24:27], v[72:75], v[84:87], v[24:27]
    s_waitcnt lgkmcnt(7)
    v_mfma_f32_16x16x32_bf16 v[28:31], v[72:75], v[88:91], v[28:31]
    v_mfma_f32_16x16x32_bf16 v[32:35], v[76:79], v[84:87], v[32:35]
    v_mfma_f32_16x16x32_bf16 v[36:39], v[76:79], v[88:91], v[36:39]
    v_mfma_f32_16x16x32_bf16 v[40:43], v[80:83], v[84:87], v[40:43]
    v_mfma_f32_16x16x32_bf16 v[44:47], v[80:83], v[88:91], v[44:47]
    s_waitcnt lgkmcnt(0)
    s_barrier
W2M_PG:
    ds_read_b128 v[112:115], v12 offset:12288
    ds_read_b128 v[116:119], v12 offset:16384
    v_mfma_f32_16x16x32_bf16 v[24:27], v[92:95], v[104:107], v[24:27]
    ds_read_b128 v[120:123], v12 offset:20480
    ds_read_b64_tr_b16 v[124:125], v20 offset:24576
    v_mfma_f32_16x16x32_bf16 v[28:31], v[92:95], v[108:111], v[28:31]
    ds_read_b64_tr_b16 v[126:127], v20 offset:25600
    ds_read_b64_tr_b16 v[128:129], v21 offset:24576
    v_mfma_f32_16x16x32_bf16 v[32:35], v[96:99], v[104:107], v[32:35]
    ds_read_b64_tr_b16 v[130:131], v21 offset:25600
    ds_read_b128 v[132:135], v13 offset:12288
    v_mfma_f32_16x16x32_bf16 v[36:39], v[96:99], v[108:111], v[36:39]
    ds_read_b128 v[136:139], v13 offset:16384
    ds_read_b128 v[140:143], v13 offset:20480
    v_mfma_f32_16x16x32_bf16 v[40:43], v[100:103], v[104:107], v[40:43]
    ds_read_b64_tr_b16 v[144:145], v20 offset:32768
    ds_read_b64_tr_b16 v[146:147], v20 offset:33792
    v_mfma_f32_16x16x32_bf16 v[44:47], v[100:103], v[108:111], v[44:47]
    ds_read_b64_tr_b16 v[148:149], v21 offset:32768
    ds_read_b64_tr_b16 v[150:151], v21 offset:33792
    s_waitcnt lgkmcnt(9)
    v_mfma_f32_16x16x32_bf16 v[24:27], v[112:115], v[124:127], v[24:27]
    s_waitcnt lgkmcnt(7)
    v_mfma_f32_16x16x32_bf16 v[28:31], v[112:115], v[128:131], v[28:31]
    v_mfma_f32_16x16x32_bf16 v[32:35], v[116:119], v[124:127], v[32:35]
    v_mfma_f32_16x16x32_bf16 v[36:39], v[116:119], v[128:131], v[36:39]
    v_mfma_f32_16x16x32_bf16 v[40:43], v[120:123], v[124:127], v[40:43]
    v_mfma_f32_16x16x32_bf16 v[44:47], v[120:123], v[128:131], v[44:47]
    s_waitcnt lgkmcnt(0)
    s_barrier
    ds_read_b128 v[72:75], v10 offset:0
    ds_read_b128 v[76:79], v10 offset:4096
    v_mfma_f32_16x16x32_bf16 v[24:27], v[132:135], v[144:147], v[24:27]
    ds_read_b128 v[80:83], v10 offset:8192
    ds_read_b64_tr_b16 v[84:85], v18 offset:0
    v_mfma_f32_16x16x32_bf16 v[28:31], v[132:135], v[148:151], v[28:31]
    ds_read_b64_tr_b16 v[86:87], v18 offset:1024
    ds_read_b64_tr_b16 v[88:89], v19 offset:0
    v_mfma_f32_16x16x32_bf16 v[32:35], v[136:139], v[144:147], v[32:35]
    ds_read_b64_tr_b16 v[90:91], v19 offset:1024
    ds_read_b128 v[92:95], v11 offset:0
    v_mfma_f32_16x16x32_bf16 v[36:39], v[136:139], v[148:151], v[36:39]
    ds_read_b128 v[96:99], v11 offset:4096
    ds_read_b128 v[100:103], v11 offset:8192
    v_mfma_f32_16x16x32_bf16 v[40:43], v[140:143], v[144:147], v[40:43]
    ds_read_b64_tr_b16 v[104:105], v18 offset:8192
    ds_read_b64_tr_b16 v[106:107], v18 offset:9216
    v_mfma_f32_16x16x32_bf16 v[44:47], v[140:143], v[148:151], v[44:47]
    ds_read_b64_tr_b16 v[108:109], v19 offset:8192
    ds_read_b64_tr_b16 v[110:111], v19 offset:9216
    s_waitcnt lgkmcnt(9)
    v_mfma_f32_16x16x32_bf16 v[24:27], v[72:75], v[84:87], v[24:27]
    s_waitcnt lgkmcnt(7)
    v_mfma_f32_16x16x32_bf16 v[28:31], v[72:75], v[88:91], v[28:31]
    v_mfma_f32_16x16x32_bf16 v[32:35], v[76:79], v[84:87], v[32:35]
    v_mfma_f32_16x16x32_bf16 v[36:39], v[76:79], v[88:91], v[36:39]
    v_mfma_f32_16x16x32_bf16 v[40:43], v[80:83], v[84:87], v[40:43]
    v_mfma_f32_16x16x32_bf16 v[44:47], v[80:83], v[88:91], v[44:47]
    s_waitcnt lgkmcnt(0)
    s_barrier
    ds_read_b128 v[112:115], v12 offset:0
    ds_read_b128 v[116:119], v12 offset:4096
    v_mfma_f32_16x16x32_bf16 v[24:27], v[92:95], v[104:107], v[24:27]
    ds_read_b128 v[120:123], v12 offset:8192
    ds_read_b64_tr_b16 v[124:125], v18 offset:16384
    v_mfma_f32_16x16x32_bf16 v[28:31], v[92:95], v[108:111], v[28:31]
    ds_read_b64_tr_b16 v[126:127], v18 offset:17408
    ds_read_b64_tr_b16 v[128:129], v19 offset:16384
    v_mfma_f32_16x16x32_bf16 v[32:35], v[96:99], v[104:107], v[32:35]
    ds_read_b64_tr_b16 v[130:131], v19 offset:17408
    ds_read_b128 v[132:135], v13 offset:0
    v_mfma_f32_16x16x32_bf16 v[36:39], v[96:99], v[108:111], v[36:39]
    ds_read_b128 v[136:139], v13 offset:4096
    ds_read_b128 v[140:143], v13 offset:8192
    v_mfma_f32_16x16x32_bf16 v[40:43], v[100:103], v[104:107], v[40:43]
    ds_read_b64_tr_b16 v[144:145], v18 offset:24576
    ds_read_b64_tr_b16 v[146:147], v18 offset:25600
    v_mfma_f32_16x16x32_bf16 v[44:47], v[100:103], v[108:111], v[44:47]
    ds_read_b64_tr_b16 v[148:149], v19 offset:24576
    ds_read_b64_tr_b16 v[150:151], v19 offset:25600
    s_waitcnt lgkmcnt(9)
    v_mfma_f32_16x16x32_bf16 v[24:27], v[112:115], v[124:127], v[24:27]
    s_waitcnt lgkmcnt(7)
    v_mfma_f32_16x16x32_bf16 v[28:31], v[112:115], v[128:131], v[28:31]
    v_mfma_f32_16x16x32_bf16 v[32:35], v[116:119], v[124:127], v[32:35]
    v_mfma_f32_16x16x32_bf16 v[36:39], v[116:119], v[128:131], v[36:39]
    v_mfma_f32_16x16x32_bf16 v[40:43], v[120:123], v[124:127], v[40:43]
    v_mfma_f32_16x16x32_bf16 v[44:47], v[120:123], v[128:131], v[44:47]
    s_waitcnt lgkmcnt(0)
    s_barrier
    ds_read_b128 v[72:75], v14 offset:24576
    ds_read_b128 v[76:79], v14 offset:28672
    v_mfma_f32_16x16x32_bf16 v[24:27], v[132:135], v[144:147], v[24:27]
    ds_read_b128 v[80:83], v14 offset:32768
    ds_read_b64_tr_b16 v[84:85], v18 offset:32768
    v_mfma_f32_16x16x32_bf16 v[28:31], v[132:135], v[148:151], v[28:31]
    ds_read_b64_tr_b16 v[86:87], v18 offset:33792
    ds_read_b64_tr_b16 v[88:89], v19 offset:32768
    v_mfma_f32_16x16x32_bf16 v[32:35], v[136:139], v[144:147], v[32:35]
    ds_read_b64_tr_b16 v[90:91], v19 offset:33792
    ds_read_b128 v[92:95], v15 offset:24576
    v_mfma_f32_16x16x32_bf16 v[36:39], v[136:139], v[148:151], v[36:39]
    ds_read_b128 v[96:99], v15 offset:28672
    ds_read_b128 v[100:103], v15 offset:32768
    v_mfma_f32_16x16x32_bf16 v[40:43], v[140:143], v[144:147], v[40:43]
    ds_read_b64_tr_b16 v[104:105], v20 offset:0
    ds_read_b64_tr_b16 v[106:107], v20 offset:1024
    v_mfma_f32_16x16x32_bf16 v[44:47], v[140:143], v[148:151], v[44:47]
    ds_read_b64_tr_b16 v[108:109], v21 offset:0
    ds_read_b64_tr_b16 v[110:111], v21 offset:1024
    s_waitcnt lgkmcnt(9)
    v_mfma_f32_16x16x32_bf16 v[48:51], v[72:75], v[84:87], 0
    v_cvt_pk_bf16_f32 v24, v24, v25
    v_cvt_pk_bf16_f32 v25, v26, v27
    v_cvt_pk_bf16_f32 v26, v28, v29
    v_cvt_pk_bf16_f32 v27, v30, v31
    buffer_store_dwordx4 v[24:27], v5, s[24:27], s44 offen sc1
    s_add_u32 s44, s44, 4096
    s_waitcnt lgkmcnt(7)
    v_mfma_f32_16x16x32_bf16 v[52:55], v[72:75], v[88:91], 0
    v_cvt_pk_bf16_f32 v32, v32, v33
    v_cvt_pk_bf16_f32 v33, v34, v35
    v_cvt_pk_bf16_f32 v34, v36, v37
    v_cvt_pk_bf16_f32 v35, v38, v39
    buffer_store_dwordx4 v[32:35], v5, s[24:27], s44 offen sc1
    s_add_u32 s44, s44, 4096
    v_mfma_f32_16x16x32_bf16 v[56:59], v[76:79], v[84:87], 0
    v_cvt_pk_bf16_f32 v40, v40, v41
    v_cvt_pk_bf16_f32 v41, v42, v43
    v_cvt_pk_bf16_f32 v42, v44, v45
    v_cvt_pk_bf16_f32 v43, v46, v47
    buffer_store_dwordx4 v[40:43], v5, s[24:27], s44 offen sc1
    s_add_u32 s44, s44, 4096
    v_mfma_f32_16x16x32_bf16 v[60:63], v[76:79], v[88:91], 0
    v_mfma_f32_16x16x32_bf16 v[64:67], v[80:83], v[84:87], 0
    v_mfma_f32_16x16x32_bf16 v[68:71], v[80:83], v[88:91], 0
    s_waitcnt lgkmcnt(0)
    s_barrier
    ds_read_b128 v[112:115], v16 offset:24576
    ds_read_b128 v[116:119], v16 offset:28672
    v_mfma_f32_16x16x32_bf16 v[48:51], v[92:95], v[104:107], v[48:51]
    ds_read_b128 v[120:123], v16 offset:32768
    ds_read_b64_tr_b16 v[124:125], v20 offset:8192
    v_mfma_f32_16x16x32_bf16 v[52:55], v[92:95], v[108:111], v[52:55]
    ds_read_b64_tr_b16 v[126:127], v20 offset:9216
    ds_read_b64_tr_b16 v[128:129], v21 offset:8192
    v_mfma_f32_16x16x32_bf16 v[56:59], v[96:99], v[104:107], v[56:59]
    ds_read_b64_tr_b16 v[130:131], v21 offset:9216
    ds_read_b128 v[132:135], v17 offset:24576
    v_mfma_f32_16x16x32_bf16 v[60:63], v[96:99], v[108:111], v[60:63]
    ds_read_b128 v[136:139], v17 offset:28672
    ds_read_b128 v[140:143], v17 offset:32768
    v_mfma_f32_16x16x32_bf16 v[64:67], v[100:103], v[104:107], v[64:67]
    ds_read_b64_tr_b16 v[144:145], v20 offset:16384
    ds_read_b64_tr_b16 v[146:147], v20 offset:17408
    v_mfma_f32_16x16x32_bf16 v[68:71], v[100:103], v[108:111], v[68:71]
    ds_read_b64_tr_b16 v[148:149], v21 offset:16384
    ds_read_b64_tr_b16 v[150:151], v21 offset:17408
    s_waitcnt lgkmcnt(9)
    v_mfma_f32_16x16x32_bf16 v[48:51], v[112:115], v[124:127], v[48:51]
    s_waitcnt lgkmcnt(7)
    v_mfma_f32_16x16x32_bf16 v[52:55], v[112:115], v[128:131], v[52:55]
    v_mfma_f32_16x16x32_bf16 v[56:59], v[116:119], v[124:127], v[56:59]
    v_mfma_f32_16x16x32_bf16 v[60:63], v[116:119], v[128:131], v[60:63]
    v_mfma_f32_16x16x32_bf16 v[64:67], v[120:123], v[124:127], v[64:67]
    v_mfma_f32_16x16x32_bf16 v[68:71], v[120:123], v[128:131], v[68:71]
    s_waitcnt lgkmcnt(0)
    s_barrier
    ds_read_b128 v[72:75], v14 offset:12288
    ds_read_b128 v[76:79], v14 offset:16384
    v_mfma_f32_16x16x32_bf16 v[48:51], v[132:135], v[144:147], v[48:51]
    ds_read_b128 v[80:83], v14 offset:20480
    ds_read_b64_tr_b16 v[84:85], v20 offset:24576
    v_mfma_f32_16x16x32_bf16 v[52:55], v[132:135], v[148:151], v[52:55]
    ds_read_b64_tr_b16 v[86:87], v20 offset:25600
    ds_read_b64_tr_b16 v[88:89], v21 offset:24576
    v_mfma_f32_16x16x32_bf16 v[56:59], v[136:139], v[144:147], v[56:59]
    ds_read_b64_tr_b16 v[90:91], v21 offset:25600
    ds_read_b128 v[92:95], v15 offset:12288
    v_mfma_f32_16x16x32_bf16 v[60:63], v[136:139], v[148:151], v[60:63]
    ds_read_b128 v[96:99], v15 offset:16384
    ds_read_b128 v[100:103], v15 offset:20480
    v_mfma_f32_16x16x32_bf16 v[64:67], v[140:143], v[144:147], v[64:67]
    ds_read_b64_tr_b16 v[104:105], v20 offset:32768
    ds_read_b64_tr_b16 v[106:107], v20 offset:33792
    v_mfma_f32_16x16x32_bf16 v[68:71], v[140:143], v[148:151], v[68:71]
    ds_read_b64_tr_b16 v[108:109], v21 offset:32768
    ds_read_b64_tr_b16 v[110:111], v21 offset:33792
    s_waitcnt lgkmcnt(9)
    v_mfma_f32_16x16x32_bf16 v[48:51], v[72:75], v[84:87], v[48:51]
    s_waitcnt lgkmcnt(7)
    v_mfma_f32_16x16x32_bf16 v[52:55], v[72:75], v[88:91], v[52:55]
    v_mfma_f32_16x16x32_bf16 v[56:59], v[76:79], v[84:87], v[56:59]
    v_mfma_f32_16x16x32_bf16 v[60:63], v[76:79], v[88:91], v[60:63]
    v_mfma_f32_16x16x32_bf16 v[64:67], v[80:83], v[84:87], v[64:67]
    v_mfma_f32_16x16x32_bf16 v[68:71], v[80:83], v[88:91], v[68:71]
    s_waitcnt lgkmcnt(0)
    s_barrier
    ds_read_b128 v[112:115], v16 offset:12288
    ds_read_b128 v[116:119], v16 offset:16384
    v_mfma_f32_16x16x32_bf16 v[48:51], v[92:95], v[104:107], v[48:51]
    ds_read_b128 v[120:123], v16 offset:20480
    ds_read_b64_tr_b16 v[124:125], v18 offset:0
    v_mfma_f32_16x16x32_bf16 v[52:55], v[92:95], v[108:111], v[52:55]
    ds_read_b64_tr_b16 v[126:127], v18 offset:1024
    ds_read_b64_tr_b16 v[128:129], v19 offset:0
    v_mfma_f32_16x16x32_bf16 v[56:59], v[96:99], v[104:107], v[56:59]
    ds_read_b64_tr_b16 v[130:131], v19 offset:1024
    ds_read_b128 v[132:135], v17 offset:12288
    v_mfma_f32_16x16x32_bf16 v[60:63], v[96:99], v[108:111], v[60:63]
    ds_read_b128 v[136:139], v17 offset:16384
    ds_read_b128 v[140:143], v17 offset:20480
    v_mfma_f32_16x16x32_bf16 v[64:67], v[100:103], v[104:107], v[64:67]
    ds_read_b64_tr_b16 v[144:145], v18 offset:8192
    ds_read_b64_tr_b16 v[146:147], v18 offset:9216
    v_mfma_f32_16x16x32_bf16 v[68:71], v[100:103], v[108:111], v[68:71]
    ds_read_b64_tr_b16 v[148:149], v19 offset:8192
    ds_read_b64_tr_b16 v[150:151], v19 offset:9216
    s_waitcnt lgkmcnt(9)
    v_mfma_f32_16x16x32_bf16 v[48:51], v[112:115], v[124:127], v[48:51]
    s_waitcnt lgkmcnt(7)
    v_mfma_f32_16x16x32_bf16 v[52:55], v[112:115], v[128:131], v[52:55]
    v_mfma_f32_16x16x32_bf16 v[56:59], v[116:119], v[124:127], v[56:59]
    v_mfma_f32_16x16x32_bf16 v[60:63], v[116:119], v[128:131], v[60:63]
    v_mfma_f32_16x16x32_bf16 v[64:67], v[120:123], v[124:127], v[64:67]
    v_mfma_f32_16x16x32_bf16 v[68:71], v[120:123], v[128:131], v[68:71]
    s_waitcnt lgkmcnt(0)
    s_barrier
    ds_read_b128 v[72:75], v14 offset:0
    ds_read_b128 v[76:79], v14 offset:4096
    v_mfma_f32_16x16x32_bf16 v[48:51], v[132:135], v[144:147], v[48:51]
    ds_read_b128 v[80:83], v14 offset:8192
    ds_read_b64_tr_b16 v[84:85], v18 offset:16384
    v_mfma_f32_16x16x32_bf16 v[52:55], v[132:135], v[148:151], v[52:55]
    ds_read_b64_tr_b16 v[86:87], v18 offset:17408
    ds_read_b64_tr_b16 v[88:89], v19 offset:16384
    v_mfma_f32_16x16x32_bf16 v[56:59], v[136:139], v[144:147], v[56:59]
    ds_read_b64_tr_b16 v[90:91], v19 offset:17408
    ds_read_b128 v[92:95], v15 offset:0
    v_mfma_f32_16x16x32_bf16 v[60:63], v[136:139], v[148:151], v[60:63]
    ds_read_b128 v[96:99], v15 offset:4096
    ds_read_b128 v[100:103], v15 offset:8192
    v_mfma_f32_16x16x32_bf16 v[64:67], v[140:143], v[144:147], v[64:67]
    ds_read_b64_tr_b16 v[104:105], v18 offset:24576
    ds_read_b64_tr_b16 v[106:107], v18 offset:25600
    v_mfma_f32_16x16x32_bf16 v[68:71], v[140:143], v[148:151], v[68:71]
    ds_read_b64_tr_b16 v[108:109], v19 offset:24576
    ds_read_b64_tr_b16 v[110:111], v19 offset:25600
    s_waitcnt lgkmcnt(9)
    v_mfma_f32_16x16x32_bf16 v[48:51], v[72:75], v[84:87], v[48:51]
    s_waitcnt lgkmcnt(7)
    v_mfma_f32_16x16x32_bf16 v[52:55], v[72:75], v[88:91], v[52:55]
    v_mfma_f32_16x16x32_bf16 v[56:59], v[76:79], v[84:87], v[56:59]
    v_mfma_f32_16x16x32_bf16 v[60:63], v[76:79], v[88:91], v[60:63]
    v_mfma_f32_16x16x32_bf16 v[64:67], v[80:83], v[84:87], v[64:67]
    v_mfma_f32_16x16x32_bf16 v[68:71], v[80:83], v[88:91], v[68:71]
    s_waitcnt vmcnt(0)
    s_mov_b64 exec, 1
    buffer_atomic_add v7, v8, s[24:27], s45 offen sc1
    s_mov_b64 exec, -1
    s_waitcnt lgkmcnt(0)
    s_barrier
    ds_read_b128 v[112:115], v16 offset:0
    ds_read_b128 v[116:119], v16 offset:4096
    v_mfma_f32_16x16x32_bf16 v[48:51], v[92:95], v[104:107], v[48:51]
    ds_read_b128 v[120:123], v16 offset:8192
    ds_read_b64_tr_b16 v[124:125], v18 offset:32768
    v_mfma_f32_16x16x32_bf16 v[52:55], v[92:95], v[108:111], v[52:55]
    ds_read_b64_tr_b16 v[126:127], v18 offset:33792
    ds_read_b64_tr_b16 v[128:129], v19 offset:32768
    v_mfma_f32_16x16x32_bf16 v[56:59], v[96:99], v[104:107], v[56:59]
    ds_read_b64_tr_b16 v[130:131], v19 offset:33792
    ds_read_b128 v[132:135], v17 offset:0
    v_mfma_f32_16x16x32_bf16 v[60:63], v[96:99], v[108:111], v[60:63]
    ds_read_b128 v[136:139], v17 offset:4096
    ds_read_b128 v[140:143], v17 offset:8192
    v_mfma_f32_16x16x32_bf16 v[64:67], v[100:103], v[104:107], v[64:67]
    ds_read_b64_tr_b16 v[144:145], v20 offset:0
    ds_read_b64_tr_b16 v[146:147], v20 offset:1024
    v_mfma_f32_16x16x32_bf16 v[68:71], v[100:103], v[108:111], v[68:71]
    ds_read_b64_tr_b16 v[148:149], v21 offset:0
    ds_read_b64_tr_b16 v[150:151], v21 offset:1024
    s_waitcnt lgkmcnt(9)
    v_mfma_f32_16x16x32_bf16 v[48:51], v[112:115], v[124:127], v[48:51]
    s_waitcnt lgkmcnt(7)
    v_mfma_f32_16x16x32_bf16 v[52:55], v[112:115], v[128:131], v[52:55]
    v_mfma_f32_16x16x32_bf16 v[56:59], v[116:119], v[124:127], v[56:59]
    v_mfma_f32_16x16x32_bf16 v[60:63], v[116:119], v[128:131], v[60:63]
    v_mfma_f32_16x16x32_bf16 v[64:67], v[120:123], v[124:127], v[64:67]
    v_mfma_f32_16x16x32_bf16 v[68:71], v[120:123], v[128:131], v[68:71]
    s_waitcnt lgkmcnt(0)
    s_barrier
    ds_read_b128 v[72:75], v10 offset:24576
    ds_read_b128 v[76:79], v10 offset:28672
    v_mfma_f32_16x16x32_bf16 v[48:51], v[132:135], v[144:147], v[48:51]
    ds_read_b128 v[80:83], v10 offset:32768
    ds_read_b64_tr_b16 v[84:85], v20 offset:8192
    v_mfma_f32_16x16x32_bf16 v[52:55], v[132:135], v[148:151], v[52:55]
    ds_read_b64_tr_b16 v[86:87], v20 offset:9216
    ds_read_b64_tr_b16 v[88:89], v21 offset:8192
    v_mfma_f32_16x16x32_bf16 v[56:59], v[136:139], v[144:147], v[56:59]
    ds_read_b64_tr_b16 v[90:91], v21 offset:9216
    ds_read_b128 v[92:95], v11 offset:24576
    v_mfma_f32_16x16x32_bf16 v[60:63], v[136:139], v[148:151], v[60:63]
    ds_read_b128 v[96:99], v11 offset:28672
    ds_read_b128 v[100:103], v11 offset:32768
    v_mfma_f32_16x16x32_bf16 v[64:67], v[140:143], v[144:147], v[64:67]
    ds_read_b64_tr_b16 v[104:105], v20 offset:16384
    ds_read_b64_tr_b16 v[106:107], v20 offset:17408
    v_mfma_f32_16x16x32_bf16 v[68:71], v[140:143], v[148:151], v[68:71]
    ds_read_b64_tr_b16 v[108:109], v21 offset:16384
    ds_read_b64_tr_b16 v[110:111], v21 offset:17408
    s_waitcnt lgkmcnt(9)
    v_mfma_f32_16x16x32_bf16 v[48:51], v[72:75], v[84:87], v[48:51]
    s_waitcnt lgkmcnt(7)
    v_mfma_f32_16x16x32_bf16 v[52:55], v[72:75], v[88:91], v[52:55]
    v_mfma_f32_16x16x32_bf16 v[56:59], v[76:79], v[84:87], v[56:59]
    v_mfma_f32_16x16x32_bf16 v[60:63], v[76:79], v[88:91], v[60:63]
    v_mfma_f32_16x16x32_bf16 v[64:67], v[80:83], v[84:87], v[64:67]
    v_mfma_f32_16x16x32_bf16 v[68:71], v[80:83], v[88:91], v[68:71]
    s_waitcnt lgkmcnt(0)
    s_barrier
    ds_read_b128 v[112:115], v12 offset:24576
    ds_read_b128 v[116:119], v12 offset:28672
    v_mfma_f32_16x16x32_bf16 v[48:51], v[92:95], v[104:107], v[48:51]
    ds_read_b128 v[120:123], v12 offset:32768
    ds_read_b64_tr_b16 v[124:125], v20 offset:24576
    v_mfma_f32_16x16x32_bf16 v[52:55], v[92:95], v[108:111], v[52:55]
    ds_read_b64_tr_b16 v[126:127], v20 offset:25600
    ds_read_b64_tr_b16 v[128:129], v21 offset:24576
    v_mfma_f32_16x16x32_bf16 v[56:59], v[96:99], v[104:107], v[56:59]
    ds_read_b64_tr_b16 v[130:131], v21 offset:25600
    ds_read_b128 v[132:135], v13 offset:24576
    v_mfma_f32_16x16x32_bf16 v[60:63], v[96:99], v[108:111], v[60:63]
    ds_read_b128 v[136:139], v13 offset:28672
    ds_read_b128 v[140:143], v13 offset:32768
    v_mfma_f32_16x16x32_bf16 v[64:67], v[100:103], v[104:107], v[64:67]
    ds_read_b64_tr_b16 v[144:145], v20 offset:32768
    ds_read_b64_tr_b16 v[146:147], v20 offset:33792
    v_mfma_f32_16x16x32_bf16 v[68:71], v[100:103], v[108:111], v[68:71]
    ds_read_b64_tr_b16 v[148:149], v21 offset:32768
    ds_read_b64_tr_b16 v[150:151], v21 offset:33792
    s_waitcnt lgkmcnt(9)
    v_mfma_f32_16x16x32_bf16 v[48:51], v[112:115], v[124:127], v[48:51]
    s_waitcnt lgkmcnt(7)
    v_mfma_f32_16x16x32_bf16 v[52:55], v[112:115], v[128:131], v[52:55]
    v_mfma_f32_16x16x32_bf16 v[56:59], v[116:119], v[124:127], v[56:59]
    v_mfma_f32_16x16x32_bf16 v[60:63], v[116:119], v[128:131], v[60:63]
    v_mfma_f32_16x16x32_bf16 v[64:67], v[120:123], v[124:127], v[64:67]
    v_mfma_f32_16x16x32_bf16 v[68:71], v[120:123], v[128:131], v[68:71]
    s_waitcnt lgkmcnt(0)
    s_barrier
    ds_read_b128 v[72:75], v10 offset:12288
    ds_read_b128 v[76:79], v10 offset:16384
    v_mfma_f32_16x16x32_bf16 v[48:51], v[132:135], v[144:147], v[48:51]
    ds_read_b128 v[80:83], v10 offset:20480
    ds_read_b64_tr_b16 v[84:85], v18 offset:0
    v_mfma_f32_16x16x32_bf16 v[52:55], v[132:135], v[148:151], v[52:55]
    ds_read_b64_tr_b16 v[86:87], v18 offset:1024
    ds_read_b64_tr_b16 v[88:89], v19 offset:0
    v_mfma_f32_16x16x32_bf16 v[56:59], v[136:139], v[144:147], v[56:59]
    ds_read_b64_tr_b16 v[90:91], v19 offset:1024
    ds_read_b128 v[92:95], v11 offset:12288
    v_mfma_f32_16x16x32_bf16 v[60:63], v[136:139], v[148:151], v[60:63]
    ds_read_b128 v[96:99], v11 offset:16384
    ds_read_b128 v[100:103], v11 offset:20480
    v_mfma_f32_16x16x32_bf16 v[64:67], v[140:143], v[144:147], v[64:67]
    ds_read_b64_tr_b16 v[104:105], v18 offset:8192
    ds_read_b64_tr_b16 v[106:107], v18 offset:9216
    v_mfma_f32_16x16x32_bf16 v[68:71], v[140:143], v[148:151], v[68:71]
    ds_read_b64_tr_b16 v[108:109], v19 offset:8192
    ds_read_b64_tr_b16 v[110:111], v19 offset:9216
    s_waitcnt lgkmcnt(9)
    v_mfma_f32_16x16x32_bf16 v[48:51], v[72:75], v[84:87], v[48:51]
    s_waitcnt lgkmcnt(7)
    v_mfma_f32_16x16x32_bf16 v[52:55], v[72:75], v[88:91], v[52:55]
    v_mfma_f32_16x16x32_bf16 v[56:59], v[76:79], v[84:87], v[56:59]
    v_mfma_f32_16x16x32_bf16 v[60:63], v[76:79], v[88:91], v[60:63]
    v_mfma_f32_16x16x32_bf16 v[64:67], v[80:83], v[84:87], v[64:67]
    v_mfma_f32_16x16x32_bf16 v[68:71], v[80:83], v[88:91], v[68:71]
    s_waitcnt lgkmcnt(0)
    s_barrier
    ds_read_b128 v[112:115], v12 offset:12288
    ds_read_b128 v[116:119], v12 offset:16384
    v_mfma_f32_16x16x32_bf16 v[48:51], v[92:95], v[104:107], v[48:51]
    ds_read_b128 v[120:123], v12 offset:20480
    ds_read_b64_tr_b16 v[124:125], v18 offset:16384
    v_mfma_f32_16x16x32_bf16 v[52:55], v[92:95], v[108:111], v[52:55]
    ds_read_b64_tr_b16 v[126:127], v18 offset:17408
    ds_read_b64_tr_b16 v[128:129], v19 offset:16384
    v_mfma_f32_16x16x32_bf16 v[56:59], v[96:99], v[104:107], v[56:59]
    ds_read_b64_tr_b16 v[130:131], v19 offset:17408
    ds_read_b128 v[132:135], v13 offset:12288
    v_mfma_f32_16x16x32_bf16 v[60:63], v[96:99], v[108:111], v[60:63]
    ds_read_b128 v[136:139], v13 offset:16384
    ds_read_b128 v[140:143], v13 offset:20480
    v_mfma_f32_16x16x32_bf16 v[64:67], v[100:103], v[104:107], v[64:67]
    ds_read_b64_tr_b16 v[144:145], v18 offset:24576
    ds_read_b64_tr_b16 v[146:147], v18 offset:25600
    v_mfma_f32_16x16x32_bf16 v[68:71], v[100:103], v[108:111], v[68:71]
    ds_read_b64_tr_b16 v[148:149], v19 offset:24576
    ds_read_b64_tr_b16 v[150:151], v19 offset:25600
    s_waitcnt lgkmcnt(9)
    v_mfma_f32_16x16x32_bf16 v[48:51], v[112:115], v[124:127], v[48:51]
    s_waitcnt lgkmcnt(7)
    v_mfma_f32_16x16x32_bf16 v[52:55], v[112:115], v[128:131], v[52:55]
    v_mfma_f32_16x16x32_bf16 v[56:59], v[116:119], v[124:127], v[56:59]
    v_mfma_f32_16x16x32_bf16 v[60:63], v[116:119], v[128:131], v[60:63]
    v_mfma_f32_16x16x32_bf16 v[64:67], v[120:123], v[124:127], v[64:67]
    v_mfma_f32_16x16x32_bf16 v[68:71], v[120:123], v[128:131], v[68:71]
    s_waitcnt lgkmcnt(0)
    s_barrier
    ds_read_b128 v[72:75], v10 offset:0
    ds_read_b128 v[76:79], v10 offset:4096
    v_mfma_f32_16x16x32_bf16 v[48:51], v[132:135], v[144:147], v[48:51]
    ds_read_b128 v[80:83], v10 offset:8192
    ds_read_b64_tr_b16 v[84:85], v18 offset:32768
    v_mfma_f32_16x16x32_bf16 v[52:55], v[132:135], v[148:151], v[52:55]
    ds_read_b64_tr_b16 v[86:87], v18 offset:33792
    ds_read_b64_tr_b16 v[88:89], v19 offset:32768
    v_mfma_f32_16x16x32_bf16 v[56:59], v[136:139], v[144:147], v[56:59]
    ds_read_b64_tr_b16 v[90:91], v19 offset:33792
    ds_read_b128 v[92:95], v11 offset:0
    v_mfma_f32_16x16x32_bf16 v[60:63], v[136:139], v[148:151], v[60:63]
    ds_read_b128 v[96:99], v11 offset:4096
    ds_read_b128 v[100:103], v11 offset:8192
    v_mfma_f32_16x16x32_bf16 v[64:67], v[140:143], v[144:147], v[64:67]
    ds_read_b64_tr_b16 v[104:105], v20 offset:0
    ds_read_b64_tr_b16 v[106:107], v20 offset:1024
    v_mfma_f32_16x16x32_bf16 v[68:71], v[140:143], v[148:151], v[68:71]
    ds_read_b64_tr_b16 v[108:109], v21 offset:0
    ds_read_b64_tr_b16 v[110:111], v21 offset:1024
    s_waitcnt lgkmcnt(9)
    v_mfma_f32_16x16x32_bf16 v[48:51], v[72:75], v[84:87], v[48:51]
    s_waitcnt lgkmcnt(7)
    v_mfma_f32_16x16x32_bf16 v[52:55], v[72:75], v[88:91], v[52:55]
    v_mfma_f32_16x16x32_bf16 v[56:59], v[76:79], v[84:87], v[56:59]
    v_mfma_f32_16x16x32_bf16 v[60:63], v[76:79], v[88:91], v[60:63]
    v_mfma_f32_16x16x32_bf16 v[64:67], v[80:83], v[84:87], v[64:67]
    v_mfma_f32_16x16x32_bf16 v[68:71], v[80:83], v[88:91], v[68:71]
    s_waitcnt lgkmcnt(0)
    s_barrier
    ds_read_b128 v[112:115], v12 offset:0
    ds_read_b128 v[116:119], v12 offset:4096
    v_mfma_f32_16x16x32_bf16 v[48:51], v[92:95], v[104:107], v[48:51]
    ds_read_b128 v[120:123], v12 offset:8192
    ds_read_b64_tr_b16 v[124:125], v20 offset:8192
    v_mfma_f32_16x16x32_bf16 v[52:55], v[92:95], v[108:111], v[52:55]
    ds_read_b64_tr_b16 v[126:127], v20 offset:9216
    ds_read_b64_tr_b16 v[128:129], v21 offset:8192
    v_mfma_f32_16x16x32_bf16 v[56:59], v[96:99], v[104:107], v[56:59]
    ds_read_b64_tr_b16 v[130:131], v21 offset:9216
    ds_read_b128 v[132:135], v13 offset:0
    v_mfma_f32_16x16x32_bf16 v[60:63], v[96:99], v[108:111], v[60:63]
    ds_read_b128 v[136:139], v13 offset:4096
    ds_read_b128 v[140:143], v13 offset:8192
    v_mfma_f32_16x16x32_bf16 v[64:67], v[100:103], v[104:107], v[64:67]
    ds_read_b64_tr_b16 v[144:145], v20 offset:16384
    ds_read_b64_tr_b16 v[146:147], v20 offset:17408
    v_mfma_f32_16x16x32_bf16 v[68:71], v[100:103], v[108:111], v[68:71]
    ds_read_b64_tr_b16 v[148:149], v21 offset:16384
    ds_read_b64_tr_b16 v[150:151], v21 offset:17408
    s_waitcnt lgkmcnt(9)
    v_mfma_f32_16x16x32_bf16 v[48:51], v[112:115], v[124:127], v[48:51]
    s_waitcnt lgkmcnt(7)
    v_mfma_f32_16x16x32_bf16 v[52:55], v[112:115], v[128:131], v[52:55]
    v_mfma_f32_16x16x32_bf16 v[56:59], v[116:119], v[124:127], v[56:59]
    v_mfma_f32_16x16x32_bf16 v[60:63], v[116:119], v[128:131], v[60:63]
    v_mfma_f32_16x16x32_bf16 v[64:67], v[120:123], v[124:127], v[64:67]
    v_mfma_f32_16x16x32_bf16 v[68:71], v[120:123], v[128:131], v[68:71]
    s_setprio 3
    s_waitcnt lgkmcnt(2)
    v_mfma_f32_16x16x32_bf16 v[48:51], v[132:135], v[144:147], v[48:51]
    s_waitcnt lgkmcnt(0)
    v_mfma_f32_16x16x32_bf16 v[52:55], v[132:135], v[148:151], v[52:55]
    v_mfma_f32_16x16x32_bf16 v[56:59], v[136:139], v[144:147], v[56:59]
    v_mfma_f32_16x16x32_bf16 v[60:63], v[136:139], v[148:151], v[60:63]
    v_mfma_f32_16x16x32_bf16 v[64:67], v[140:143], v[144:147], v[64:67]
    v_mfma_f32_16x16x32_bf16 v[68:71], v[140:143], v[148:151], v[68:71]
    s_barrier
    ds_read_b128 v[152:155], v6 offset:0
    ds_read_b128 v[156:159], v6 offset:4096
    ds_read_b128 v[160:163], v6 offset:8192
    s_nop 4
    v_pk_mul_f32 v[48:49], v[48:49], s[54:55]
    v_pk_mul_f32 v[50:51], v[50:51], s[54:55]
    v_pk_mul_f32 v[52:53], v[52:53], s[54:55]
    v_pk_mul_f32 v[54:55], v[54:55], s[54:55]
    v_pk_mul_f32 v[56:57], v[56:57], s[54:55]
    v_pk_mul_f32 v[58:59], v[58:59], s[54:55]
    v_pk_mul_f32 v[60:61], v[60:61], s[54:55]
    v_pk_mul_f32 v[62:63], v[62:63], s[54:55]
    v_pk_mul_f32 v[64:65], v[64:65], s[54:55]
    v_pk_mul_f32 v[66:67], v[66:67], s[54:55]
    v_pk_mul_f32 v[68:69], v[68:69], s[54:55]
    v_pk_mul_f32 v[70:71], v[70:71], s[54:55]
    s_waitcnt lgkmcnt(2)
    v_dot2c_f32_bf16 v48, s56, v152
    v_dot2c_f32_bf16 v49, s57, v152
    v_dot2c_f32_bf16 v50, s56, v153
    v_dot2c_f32_bf16 v51, s57, v153
    v_dot2c_f32_bf16 v52, s56, v154
    v_dot2c_f32_bf16 v53, s57, v154
    v_dot2c_f32_bf16 v54, s56, v155
    v_dot2c_f32_bf16 v55, s57, v155
    s_nop 2
    v_cvt_pk_bf16_f32 v72, v48, v49
    v_cvt_pk_bf16_f32 v73, v50, v51
    v_cvt_pk_bf16_f32 v74, v52, v53
    v_cvt_pk_bf16_f32 v75, v54, v55
    s_nop 1
    v_permlane32_swap_b32 v72, v74
    v_permlane32_swap_b32 v73, v75
    buffer_store_dwordx4 v[72:75], v22, s[24:27], s50 offen offset:0 sc1
    s_cmp_eq_u32 s40, 13
    s_cbranch_scc1 W2M_END
    s_waitcnt lgkmcnt(1)
    v_dot2c_f32_bf16 v56, s56, v156
    v_dot2c_f32_bf16 v57, s57, v156
    v_dot2c_f32_bf16 v58, s56, v157
    v_dot2c_f32_bf16 v59, s57, v157
    v_dot2c_f32_bf16 v60, s56, v158
    v_dot2c_f32_bf16 v61, s57, v158
    v_dot2c_f32_bf16 v62, s56, v159
    v_dot2c_f32_bf16 v63, s57, v159
    s_nop 2
    v_cvt_pk_bf16_f32 v76, v56, v57
    v_cvt_pk_bf16_f32 v77, v58, v59
    v_cvt_pk_bf16_f32 v78, v60, v61
    v_cvt_pk_bf16_f32 v79, v62, v63
    s_nop 1
    v_permlane32_swap_b32 v76, v78
    v_permlane32_swap_b32 v77, v79
    buffer_store_dwordx4 v[76:79], v22, s[24:27], s50 offen offset:1024 sc1
    s_waitcnt lgkmcnt(0)
    v_dot2c_f32_bf16 v64, s56, v160
    v_dot2c_f32_bf16 v65, s57, v160
    v_dot2c_f32_bf16 v66, s56, v161
    v_dot2c_f32_bf16 v67, s57, v161
    v_dot2c_f32_bf16 v68, s56, v162
    v_dot2c_f32_bf16 v69, s57, v162
    v_dot2c_f32_bf16 v70, s56, v163
    v_dot2c_f32_bf16 v71, s57, v163
    s_nop 2
    v_cvt_pk_bf16_f32 v80, v64, v65
    v_cvt_pk_bf16_f32 v81, v66, v67
    v_cvt_pk_bf16_f32 v82, v68, v69
    v_cvt_pk_bf16_f32 v83, v70, v71
    s_nop 1
    v_permlane32_swap_b32 v80, v82
    v_permlane32_swap_b32 v81, v83
    buffer_store_dwordx4 v[80:83], v22, s[24:27], s50 offen offset:2048 sc1
W2M_END:
    v_mov_b32 v4, 155648
    s_mov_b64 exec, 1
    ds_add_u32 v4, v7 offset:12
    s_mov_b64 exec, -1
    s_branch P2_PUB
P1_XR:
    s_sub_u32 s4, s3, 21
    s_cmp_ge_u32 s4, 5
    s_cselect_b32 s5, 1, 0
    s_cselect_b32 s6, 5, 0
    s_sub_u32 s41, s4, s6
    s_lshl_b32 s7, s37, 1
    s_add_u32 s40, s7, s5
    s_cmp_ge_u32 s3, 31
    s_cbranch_scc1 IDLE_WG
    s_cmp_lt_u32 s36, 4
    s_cbranch_scc1 XR_MFMA
    s_cmp_lt_u32 s36, 6
    s_cbranch_scc1 XR_LD
    v_and_b32 v2, 7, v1
    v_lshlrev_b32 v2, 2, v2
    v_lshlrev_b32 v6, 7, v1
    s_mul_i32 s4, s40, 5
    s_add_u32 s4, s4, s41
    s_lshl_b32 s5, s4, 15
    s_lshl_b32 s6, s4, 14
    s_mov_b32 s30, 2621440
    s_mov_b32 s31, 0x00020000
    s_mov_b32 s34, 819200
    s_mov_b32 s35, 0x00020000
    s_waitcnt lgkmcnt(0)
    s_cmp_lg_u32 s36, 6
    s_cbranch_scc1 XR_TU
    buffer_load_dword v8, v6, s[28:31], s5 offen
    s_add_u32 s5, s5, 8192
    buffer_load_dword v9, v6, s[28:31], s5 offen
    s_add_u32 s5, s5, 8192
    buffer_load_dword v10, v6, s[28:31], s5 offen
    s_add_u32 s5, s5, 8192
    buffer_load_dword v11, v6, s[28:31], s5 offen
    s_branch XR_TX
XR_TU:
    buffer_load_dword v12, v6, s[32:35], s6 offen
    s_add_u32 s6, s6, 8192
    buffer_load_dword v13, v6, s[32:35], s6 offen
XR_TX:
    s_cmp_lg_u32 s36, 7
    s_cbranch_scc1 XR_W6
    s_sub_u32 s4, s3, 21
    s_mov_b32 s48, 0x818b0
    s_cmp_eq_u32 s4, 1
    s_cselect_b32 s48, 0x858c0, s48
    s_cmp_eq_u32 s4, 2
    s_cselect_b32 s48, 0x898d0, s48
    s_cmp_eq_u32 s4, 3
    s_cselect_b32 s48, 0xa1ce0, s48
    s_cmp_eq_u32 s4, 4
    s_cselect_b32 s48, 0xa5cf0, s48
    s_cmp_eq_u32 s4, 5
    s_cselect_b32 s48, 0x80060d30, s48
    s_cmp_eq_u32 s4, 6
    s_cselect_b32 s48, 0x80064d40, s48
    s_cmp_eq_u32 s4, 7
    s_cselect_b32 s48, 0x80068d50, s48
    s_cmp_eq_u32 s4, 8
    s_cselect_b32 s48, 0x800a9d60, s48
    s_cmp_eq_u32 s4, 9
    s_cselect_b32 s48, 0x80000170, s48
    s_mov_b32 s49, 14
TP:
    s_mov_b32 s14, 4718592
    s_mov_b32 s10, 3932160
    s_bfe_u32 s58, s37, 0x10001
    s_lshr_b32 s5, s37, 2
    s_and_b32 s6, s37, 1
    s_mul_i32 s46, s5, 196608
    s_mul_i32 s4, s58, 2359552
    s_add_u32 s46, s46, s4
    s_mul_i32 s4, s6, 1536
    s_add_u32 s46, s46, s4
    s_lshl1_add_u32 s47, s5, s6
    s_mul_i32 s47, s47, 983040
    s_mul_i32 s4, s58, 3072
    s_add_u32 s47, s47, s4
    s_sub_u32 s47, s47, 589824
    s_mov_b32 s59, s49
    v_lshrrev_b32 v40, 2, v1
    v_mul_u32_u24 v40, 0x1800, v40
    v_and_b32 v3, 3, v1
    v_lshl_add_u32 v40, v3, 7, v40
    v_add_u32 v41, 98304, v40
    v_and_b32 v3, 1, v1
    v_lshlrev_b32 v3, 7, v3
    v_lshrrev_b32 v4, 1, v1
    v_lshl_add_u32 v44, v4, 9, v3
    v_add_u32 v45, 0x4000, v44
    s_bitcmp0_b32 s48, 31
    s_cbranch_scc1 TP_L
    s_bitset0_b32 s48, 31
    s_sleep 40
TP_L:
    s_and_b32 s4, s48, 15
    s_sub_u32 s49, s49, s4
    s_branch TP_W1
TP_W0:
    s_cmp_eq_u32 s59, 0
    s_cbranch_scc1 TP_S
    s_barrier
    s_branch TP_W1
TP_S:
    s_sleep 16
TP_W1:
    s_sub_u32 s4, s4, 1
    s_cbranch_scc0 TP_W0
    s_bfe_u32 s5, s48, 0x30004
    s_bfe_u32 s6, s48, 0x30007
    s_lshr_b32 s48, s48, 10
    s_cmp_eq_u32 s6, 0
    s_cbranch_scc1 TP_X
    s_cmp_ge_u32 s5, 3
    s_cbranch_scc1 TP_Q
    s_lshl_b32 s4, s5, 7
    v_add_u32 v3, s4, v1
    v_add_u32 v4, 64, v3
    v_mul_u32_u24 v3, 171, v3
    v_mul_u32_u24 v4, 171, v4
    v_lshrrev_b32 v3, 10, v3
    v_lshrrev_b32 v4, 10, v4
    v_mul_u32_u24 v3, 1536, v3
    v_mul_u32_u24 v4, 1536, v4
    v_add_u32 v42, v44, v3
    v_add_u32 v43, v45, v4
    s_lshl_b32 s4, s5, 15
    s_add_u32 s4, s4, s46
    s_cmp_ge_u32 s6, 3
    s_cselect_b32 s5, 256, 0
    s_cselect_b32 s7, 3, 0
    s_xor_b32 s4, s4, s5
    s_sub_u32 s6, s6, s7
    s_mul_i32 s6, s6, 786432
    s_add_u32 s4, s4, s6
    s_add_u32 s5, s4, 393216
    buffer_load_dword v16, v42, s[12:15], s4 offen
    buffer_load_dword v17, v43, s[12:15], s4 offen
    buffer_load_dword v18, v42, s[12:15], s5 offen
    buffer_load_dword v19, v43, s[12:15], s5 offen
    s_branch TP_L
TP_Q:
    s_mul_i32 s4, s5, 196608
    s_add_u32 s4, s4, s47
    s_lshl_b32 s6, s6, 10
    s_add_u32 s4, s4, s6
    buffer_load_dword v16, v40, s[8:11], s4 offen
    buffer_load_dword v17, v41, s[8:11], s4 offen
    buffer_load_dword v18, v40, s[8:11], s4 offen offset:512
    buffer_load_dword v19, v41, s[8:11], s4 offen offset:512
    s_branch TP_L
TP_X:
    s_cmp_eq_u32 s59, 0
    s_cbranch_scc1 IDLE_G_X
    s_branch TP_E1
TP_E0:
    s_barrier
TP_E1:
    s_sub_u32 s49, s49, 1
    s_cbranch_scc0 TP_E0
    s_branch P2_MMX
XR_W6:
    s_barrier
    s_barrier
    s_barrier
    s_barrier
    s_barrier
    s_barrier
    buffer_load_dword v3, v2, s[92:95], 0 offen sc1
    s_barrier
    s_barrier
    s_barrier
    s_barrier
    s_mov_b32 s7, 40000
    s_waitcnt vmcnt(0)
    s_branch XR_G_C
    s_mov_b32 s7, 40000
XR_G:
    s_sub_u32 s7, s7, 1
    s_cbranch_scc1 XR_G_X
    buffer_load_dword v3, v2, s[92:95], 0 offen sc1
    s_waitcnt vmcnt(0)
XR_G_C:
    v_cmp_ne_u32 vcc, 0, v3
    s_cmp_eq_u64 vcc, -1
    s_cbranch_scc0 XR_G
XR_G_X:
    s_barrier
    s_barrier
    s_barrier
    s_barrier
    s_branch P2_MMX
IDLE_WG:
    v_and_b32 v2, 7, v1
    v_lshlrev_b32 v2, 2, v2
    s_mov_b32 s48, 0x0
    s_cmp_eq_u32 s36, 1
    s_cselect_b32 s48, 0x80, s48
    s_cmp_eq_u32 s36, 2
    s_cselect_b32 s48, 0x90, s48
    s_cmp_eq_u32 s36, 3
    s_cselect_b32 s48, 0xa0, s48
    s_cmp_eq_u32 s36, 4
    s_cselect_b32 s48, 0x103, s48
    s_cmp_eq_u32 s36, 5
    s_cselect_b32 s48, 0x113, s48
    s_cmp_eq_u32 s36, 6
    s_cselect_b32 s48, 0x123, s48
    s_cmp_eq_u32 s36, 7
    s_cselect_b32 s48, 0x0, s48
    s_mov_b32 s49, 0
    s_cmp_lg_u32 s36, 0
    s_waitcnt lgkmcnt(0)
    s_cbranch_scc1 TP
    s_setprio 3
    v_mov_b32 v6, 0
    v_mov_b32 v7, 0
    v_mov_b32 v8, 0
    v_mov_b32 v9, 0
    s_mul_i32 s4, s37, 12288
    s_add_u32 s4, s4, 4587520
    buffer_store_dwordx4 v[6:9], v5, s[24:27], s4 offen offset:0 sc1
    buffer_store_dwordx4 v[6:9], v5, s[24:27], s4 offen offset:1024 sc1
    buffer_store_dwordx4 v[6:9], v5, s[24:27], s4 offen offset:2048 sc1
    buffer_store_dwordx4 v[6:9], v5, s[24:27], s4 offen offset:3072 sc1
    s_add_u32 s4, s4, 4096
    buffer_store_dwordx4 v[6:9], v5, s[24:27], s4 offen offset:0 sc1
    buffer_store_dwordx4 v[6:9], v5, s[24:27], s4 offen offset:1024 sc1
    buffer_store_dwordx4 v[6:9], v5, s[24:27], s4 offen offset:2048 sc1
    buffer_store_dwordx4 v[6:9], v5, s[24:27], s4 offen offset:3072 sc1
    s_add_u32 s4, s4, 4096
    buffer_store_dwordx4 v[6:9], v5, s[24:27], s4 offen offset:0 sc1
    buffer_store_dwordx4 v[6:9], v5, s[24:27], s4 offen offset:1024 sc1
    buffer_store_dwordx4 v[6:9], v5, s[24:27], s4 offen offset:2048 sc1
    buffer_store_dwordx4 v[6:9], v5, s[24:27], s4 offen offset:3072 sc1
    s_lshl_b32 s4, s37, 2
    v_mov_b32 v4, 1
    s_waitcnt vmcnt(0)
    s_mov_b64 exec, 1
    buffer_store_dword v4, v6, s[92:95], s4 offen sc1
    s_mov_b64 exec, -1
    s_setprio 0
    s_mov_b32 s7, 40000
    s_branch IDLE_G_1
IDLE_G:
    s_sleep 8
IDLE_G_1:
    s_sub_u32 s7, s7, 1
    s_cbranch_scc1 IDLE_G_X
    buffer_load_dword v3, v2, s[92:95], 0 offen sc1
    s_waitcnt vmcnt(0)
IDLE_G_C:
    v_cmp_ne_u32 vcc, 0, v3
    s_cmp_eq_u64 vcc, -1
    s_cbranch_scc0 IDLE_G
IDLE_G_X:
    s_barrier
    s_mov_b32 s60, 0
    s_cmp_lt_u32 s36, 4
    s_cbranch_scc1 P2_LD
    s_branch P2_MMI
XR_LD:
    v_lshrrev_b32 v3, 4, v1
    s_mov_b32 s31, 0x00020000
    s_mov_b32 s48, 0
    s_cmp_eq_u32 s36, 4
    s_cbranch_scc0 XRL_U
    v_lshrrev_b32 v2, 3, v1
    v_and_b32 v4, 7, v1
    v_xor_b32 v4, v4, v3
    v_lshlrev_b32 v4, 4, v4
    v_mul_u32_u24 v6, 0x500, v2
    v_add_u32 v6, v6, v4
    v_xor_b32 v4, 64, v6
    v_add_u32 v7, 9216, v4
    v_add_u32 v8, 18432, v6
    v_add_u32 v9, 27648, v4
    s_mul_i32 s43, s40, 163840
    s_mov_b32 m0, 0
    s_mov_b32 s30, 2621440
    s_waitcnt lgkmcnt(0)
XRL_XL:
    buffer_load_dwordx4 v6, s[28:31], s43 offen offset:0 lds
    buffer_load_dwordx4 v7, s[28:31], s43 offen offset:1024 lds
    buffer_load_dwordx4 v8, s[28:31], s43 offen offset:2048 lds
    buffer_load_dwordx4 v9, s[28:31], s43 offen offset:3072 lds
    s_add_u32 m0, m0, 4096
    s_add_u32 s43, s43, 40960
    buffer_load_dwordx4 v6, s[28:31], s43 offen offset:0 lds
    buffer_load_dwordx4 v7, s[28:31], s43 offen offset:1024 lds
    buffer_load_dwordx4 v8, s[28:31], s43 offen offset:2048 lds
    buffer_load_dwordx4 v9, s[28:31], s43 offen offset:3072 lds
    s_add_u32 s43, s43, 4294926464
    s_add_u32 m0, m0, 20480
    s_cmp_ge_u32 m0, 147456
    s_cselect_b32 m0, 0, m0
    s_add_u32 s48, s48, 1
    s_cmp_lt_u32 s48, 3
    s_cbranch_scc1 XRL_XL
    s_waitcnt vmcnt(16)
    s_barrier
    s_cmp_lt_u32 s48, 10
    s_cbranch_scc1 XRL_XL
    s_add_u32 s43, s43, 80640
    buffer_load_dwordx4 v6, s[28:31], s43 offen offset:0 lds
    buffer_load_dwordx4 v7, s[28:31], s43 offen offset:1024 lds
    buffer_load_dwordx4 v8, s[28:31], s43 offen offset:2048 lds
    buffer_load_dwordx4 v9, s[28:31], s43 offen offset:3072 lds
    s_add_u32 s43, s43, 128
    s_add_u32 m0, m0, 4096
    s_nop 0
    buffer_load_dwordx4 v6, s[28:31], s43 offen offset:0 lds
    buffer_load_dwordx4 v7, s[28:31], s43 offen offset:1024 lds
    buffer_load_dwordx4 v8, s[28:31], s43 offen offset:2048 lds
    buffer_load_dwordx4 v9, s[28:31], s43 offen offset:3072 lds
    s_add_u32 s43, s43, 128
    s_add_u32 m0, m0, 4096
    s_nop 0
    buffer_load_dwordx4 v6, s[28:31], s43 offen offset:0 lds
    buffer_load_dwordx4 v7, s[28:31], s43 offen offset:1024 lds
    buffer_load_dwordx4 v8, s[28:31], s43 offen offset:2048 lds
    buffer_load_dwordx4 v9, s[28:31], s43 offen offset:3072 lds
    s_add_u32 s43, s43, 128
    s_add_u32 m0, m0, 4096
    s_nop 0
    buffer_load_dwordx4 v6, s[28:31], s43 offen offset:0 lds
    buffer_load_dwordx4 v7, s[28:31], s43 offen offset:1024 lds
    buffer_load_dwordx4 v8, s[28:31], s43 offen offset:2048 lds
    buffer_load_dwordx4 v9, s[28:31], s43 offen offset:3072 lds
    s_add_u32 s43, s43, 128
    s_add_u32 m0, m0, 4096
    s_nop 0
    buffer_load_dwordx4 v6, s[28:31], s43 offen offset:0 lds
    buffer_load_dwordx4 v7, s[28:31], s43 offen offset:1024 lds
    buffer_load_dwordx4 v8, s[28:31], s43 offen offset:2048 lds
    buffer_load_dwordx4 v9, s[28:31], s43 offen offset:3072 lds
    s_add_u32 s43, s43, 128
    s_add_u32 m0, m0, 8192
    s_cmp_ge_u32 m0, 147456
    s_cselect_b32 m0, 0, m0
    s_waitcnt vmcnt(28)
    s_barrier
    buffer_load_dwordx4 v6, s[28:31], s43 offen offset:0 lds
    buffer_load_dwordx4 v7, s[28:31], s43 offen offset:1024 lds
    buffer_load_dwordx4 v8, s[28:31], s43 offen offset:2048 lds
    buffer_load_dwordx4 v9, s[28:31], s43 offen offset:3072 lds
    s_add_u32 s43, s43, 128
    s_add_u32 m0, m0, 4096
    s_nop 0
    buffer_load_dwordx4 v6, s[28:31], s43 offen offset:0 lds
    buffer_load_dwordx4 v7, s[28:31], s43 offen offset:1024 lds
    buffer_load_dwordx4 v8, s[28:31], s43 offen offset:2048 lds
    buffer_load_dwordx4 v9, s[28:31], s43 offen offset:3072 lds
    s_add_u32 s43, s43, 128
    s_add_u32 m0, m0, 4096
    s_nop 0
    buffer_load_dwordx4 v6, s[28:31], s43 offen offset:0 lds
    buffer_load_dwordx4 v7, s[28:31], s43 offen offset:1024 lds
    buffer_load_dwordx4 v8, s[28:31], s43 offen offset:2048 lds
    buffer_load_dwordx4 v9, s[28:31], s43 offen offset:3072 lds
    s_add_u32 s43, s43, 128
    s_add_u32 m0, m0, 4096
    s_nop 0
    buffer_load_dwordx4 v6, s[28:31], s43 offen offset:0 lds
    buffer_load_dwordx4 v7, s[28:31], s43 offen offset:1024 lds
    buffer_load_dwordx4 v8, s[28:31], s43 offen offset:2048 lds
    buffer_load_dwordx4 v9, s[28:31], s43 offen offset:3072 lds
    s_add_u32 s43, s43, 128
    s_add_u32 m0, m0, 4096
    s_nop 0
    buffer_load_dwordx4 v6, s[28:31], s43 offen offset:0 lds
    buffer_load_dwordx4 v7, s[28:31], s43 offen offset:1024 lds
    buffer_load_dwordx4 v8, s[28:31], s43 offen offset:2048 lds
    buffer_load_dwordx4 v9, s[28:31], s43 offen offset:3072 lds
    s_add_u32 s43, s43, 39808
    s_add_u32 m0, m0, 8192
    s_cmp_ge_u32 m0, 147456
    s_cselect_b32 m0, 0, m0
    s_waitcnt vmcnt(40)
    s_barrier
    buffer_load_dwordx4 v6, s[28:31], s43 offen offset:0 lds
    buffer_load_dwordx4 v7, s[28:31], s43 offen offset:1024 lds
    buffer_load_dwordx4 v8, s[28:31], s43 offen offset:2048 lds
    buffer_load_dwordx4 v9, s[28:31], s43 offen offset:3072 lds
    s_add_u32 s43, s43, 128
    s_add_u32 m0, m0, 4096
    s_nop 0
    buffer_load_dwordx4 v6, s[28:31], s43 offen offset:0 lds
    buffer_load_dwordx4 v7, s[28:31], s43 offen offset:1024 lds
    buffer_load_dwordx4 v8, s[28:31], s43 offen offset:2048 lds
    buffer_load_dwordx4 v9, s[28:31], s43 offen offset:3072 lds
    s_add_u32 s43, s43, 128
    s_add_u32 m0, m0, 4096
    s_nop 0
    buffer_load_dwordx4 v6, s[28:31], s43 offen offset:0 lds
    buffer_load_dwordx4 v7, s[28:31], s43 offen offset:1024 lds
    buffer_load_dwordx4 v8, s[28:31], s43 offen offset:2048 lds
    buffer_load_dwordx4 v9, s[28:31], s43 offen offset:3072 lds
    s_add_u32 s43, s43, 128
    s_add_u32 m0, m0, 4096
    s_nop 0
    buffer_load_dwordx4 v6, s[28:31], s43 offen offset:0 lds
    buffer_load_dwordx4 v7, s[28:31], s43 offen offset:1024 lds
    buffer_load_dwordx4 v8, s[28:31], s43 offen offset:2048 lds
    buffer_load_dwordx4 v9, s[28:31], s43 offen offset:3072 lds
    s_add_u32 s43, s43, 128
    s_add_u32 m0, m0, 4096
    s_nop 0
    buffer_load_dwordx4 v6, s[28:31], s43 offen offset:0 lds
    buffer_load_dwordx4 v7, s[28:31], s43 offen offset:1024 lds
    buffer_load_dwordx4 v8, s[28:31], s43 offen offset:2048 lds
    buffer_load_dwordx4 v9, s[28:31], s43 offen offset:3072 lds
    s_add_u32 s43, s43, 128
    s_add_u32 m0, m0, 8192
    s_cmp_ge_u32 m0, 147456
    s_cselect_b32 m0, 0, m0
    s_waitcnt vmcnt(40)
    s_barrier
    buffer_load_dwordx4 v6, s[28:31], s43 offen offset:0 lds
    buffer_load_dwordx4 v7, s[28:31], s43 offen offset:1024 lds
    buffer_load_dwordx4 v8, s[28:31], s43 offen offset:2048 lds
    buffer_load_dwordx4 v9, s[28:31], s43 offen offset:3072 lds
    s_add_u32 s43, s43, 128
    s_add_u32 m0, m0, 4096
    s_nop 0
    buffer_load_dwordx4 v6, s[28:31], s43 offen offset:0 lds
    buffer_load_dwordx4 v7, s[28:31], s43 offen offset:1024 lds
    buffer_load_dwordx4 v8, s[28:31], s43 offen offset:2048 lds
    buffer_load_dwordx4 v9, s[28:31], s43 offen offset:3072 lds
    s_add_u32 s43, s43, 128
    s_add_u32 m0, m0, 4096
    s_nop 0
    buffer_load_dwordx4 v6, s[28:31], s43 offen offset:0 lds
    buffer_load_dwordx4 v7, s[28:31], s43 offen offset:1024 lds
    buffer_load_dwordx4 v8, s[28:31], s43 offen offset:2048 lds
    buffer_load_dwordx4 v9, s[28:31], s43 offen offset:3072 lds
    s_add_u32 s43, s43, 128
    s_add_u32 m0, m0, 4096
    s_nop 0
    buffer_load_dwordx4 v6, s[28:31], s43 offen offset:0 lds
    buffer_load_dwordx4 v7, s[28:31], s43 offen offset:1024 lds
    buffer_load_dwordx4 v8, s[28:31], s43 offen offset:2048 lds
    buffer_load_dwordx4 v9, s[28:31], s43 offen offset:3072 lds
    s_add_u32 s43, s43, 128
    s_add_u32 m0, m0, 4096
    s_nop 0
    buffer_load_dwordx4 v6, s[28:31], s43 offen offset:0 lds
    buffer_load_dwordx4 v7, s[28:31], s43 offen offset:1024 lds
    buffer_load_dwordx4 v8, s[28:31], s43 offen offset:2048 lds
    buffer_load_dwordx4 v9, s[28:31], s43 offen offset:3072 lds
    s_add_u32 s43, s43, 39808
    s_add_u32 m0, m0, 8192
    s_cmp_ge_u32 m0, 147456
    s_cselect_b32 m0, 0, m0
    s_waitcnt vmcnt(40)
    s_barrier
    s_waitcnt vmcnt(20)
    s_barrier
    s_waitcnt vmcnt(0)
    s_barrier
    s_branch P2_MMX
XRL_U:
    v_and_b32 v4, 15, v1
    v_lshlrev_b32 v2, 2, v3
    v_xor_b32 v4, v4, v2
    v_lshlrev_b32 v4, 4, v4
    v_mul_u32_u24 v6, 0x500, v3
    v_add_u32 v6, v6, v4
    v_add_u32 v7, 4096, v6
    v_add_u32 v8, 8192, v6
    v_add_u32 v9, 12288, v6
    s_lshl_b32 s43, s41, 8
    s_mov_b32 m0, 8192
    s_mov_b32 s30, 819200
    s_waitcnt lgkmcnt(0)
    s_mov_b32 s28, s32
    s_mov_b32 s29, s33
XRL_UL:
    buffer_load_dwordx4 v6, s[28:31], s43 offen offset:0 lds
    buffer_load_dwordx4 v7, s[28:31], s43 offen offset:1024 lds
    buffer_load_dwordx4 v8, s[28:31], s43 offen offset:2048 lds
    buffer_load_dwordx4 v9, s[28:31], s43 offen offset:3072 lds
    s_add_u32 s43, s43, 20480
    s_add_u32 m0, m0, 4096
    s_nop 0
    buffer_load_dwordx4 v6, s[28:31], s43 offen offset:0 lds
    buffer_load_dwordx4 v7, s[28:31], s43 offen offset:1024 lds
    buffer_load_dwordx4 v8, s[28:31], s43 offen offset:2048 lds
    buffer_load_dwordx4 v9, s[28:31], s43 offen offset:3072 lds
    s_add_u32 s43, s43, 20480
    s_add_u32 m0, m0, 4096
    s_nop 0
    buffer_load_dwordx4 v6, s[28:31], s43 offen offset:0 lds
    buffer_load_dwordx4 v7, s[28:31], s43 offen offset:1024 lds
    buffer_load_dwordx4 v8, s[28:31], s43 offen offset:2048 lds
    buffer_load_dwordx4 v9, s[28:31], s43 offen offset:3072 lds
    s_add_u32 s43, s43, 20480
    s_add_u32 m0, m0, 4096
    s_nop 0
    buffer_load_dwordx4 v6, s[28:31], s43 offen offset:0 lds
    buffer_load_dwordx4 v7, s[28:31], s43 offen offset:1024 lds
    buffer_load_dwordx4 v8, s[28:31], s43 offen offset:2048 lds
    buffer_load_dwordx4 v9, s[28:31], s43 offen offset:3072 lds
    s_add_u32 s43, s43, 20480
    s_add_u32 m0, m0, 12288
    s_cmp_ge_u32 m0, 147456
    s_cselect_b32 m0, 8192, m0
    s_add_u32 s48, s48, 1
    s_cmp_lt_u32 s48, 3
    s_cbranch_scc1 XRL_UL
    s_waitcnt vmcnt(32)
    s_barrier
    s_cmp_lt_u32 s48, 10
    s_cbranch_scc1 XRL_UL
    s_waitcnt vmcnt(16)
    s_barrier
    s_waitcnt vmcnt(0)
    s_barrier
    s_barrier
    s_barrier
    s_barrier
    s_barrier
    s_branch P2_MMX
XR_MFMA:
    v_and_b32 v3, 31, v1
    v_bfe_u32 v4, v1, 1, 3
    v_lshrrev_b32 v11, 5, v1
    v_xor_b32 v4, v4, v11
    v_lshlrev_b32 v4, 4, v4
    v_lshl_add_u32 v6, v3, 7, v4
    v_xor_b32 v7, 32, v6
    v_xor_b32 v8, 64, v6
    v_xor_b32 v9, 96, v6
    v_bfe_u32 v2, v1, 4, 1
    v_bfe_u32 v3, v1, 2, 2
    v_xor_b32 v4, s36, v3
    v_lshlrev_b32 v4, 6, v4
    v_lshl_add_u32 v4, v3, 8, v4
    v_lshl_add_u32 v4, v11, 11, v4
    v_lshl_add_u32 v4, v2, 5, v4
    v_and_b32 v3, 3, v1
    v_lshl_add_u32 v10, v3, 3, v4
    s_mul_i32 s6, s40, 160
    s_lshl_b32 s7, s41, 3
    s_add_u32 s6, s6, s7
    s_lshl_b32 s7, s36, 1
    s_add_u32 s6, s6, s7
    s_lshl_b32 s50, s6, 10
    s_mov_b32 s53, 7
    s_lshl_b32 s51, s40, 11
    s_add_u32 s51, s51, 4620288
    s_waitcnt vmcnt(0) lgkmcnt(0)
    v_mov_b32 v2, 1
    v_lshlrev_b32 v3, 7, v1
    s_barrier
    ds_read_b64_tr_b16 v[96:97], v10 offset:8192
    ds_read_b64_tr_b16 v[98:99], v10 offset:9216
    ds_read_b128 v[64:67], v6 offset:0
    ds_read_b128 v[68:71], v6 offset:4096
    ds_read_b64_tr_b16 v[100:101], v10 offset:12288
    ds_read_b64_tr_b16 v[102:103], v10 offset:13312
    ds_read_b128 v[72:75], v7 offset:0
    ds_read_b128 v[76:79], v7 offset:4096
    ds_read_b64_tr_b16 v[104:105], v10 offset:16384
    ds_read_b64_tr_b16 v[106:107], v10 offset:17408
    ds_read_b128 v[80:83], v8 offset:0
    ds_read_b128 v[84:87], v8 offset:4096
    ds_read_b64_tr_b16 v[108:109], v10 offset:20480
    ds_read_b64_tr_b16 v[110:111], v10 offset:21504
    ds_read_b128 v[88:91], v9 offset:0
    s_waitcnt lgkmcnt(12)
    v_mfma_f32_32x32x16_bf16 v[16:31], v[96:99], v[64:67], 0
    ds_read_b128 v[92:95], v9 offset:4096
    s_waitcnt lgkmcnt(12)
    v_mfma_f32_32x32x16_bf16 v[32:47], v[96:99], v[68:71], 0
    s_barrier
    ds_read_b64_tr_b16 v[112:113], v10 offset:32768
    ds_read_b64_tr_b16 v[114:115], v10 offset:33792
    ds_read_b128 v[64:67], v6 offset:24576
    s_waitcnt lgkmcnt(12)
    v_mfma_f32_32x32x16_bf16 v[16:31], v[100:103], v[72:75], v[16:31]
    ds_read_b128 v[68:71], v6 offset:28672
    s_waitcnt lgkmcnt(12)
    v_mfma_f32_32x32x16_bf16 v[32:47], v[100:103], v[76:79], v[32:47]
    ds_read_b64_tr_b16 v[116:117], v10 offset:36864
    ds_read_b64_tr_b16 v[118:119], v10 offset:37888
    ds_read_b128 v[72:75], v7 offset:24576
    s_waitcnt lgkmcnt(12)
    v_mfma_f32_32x32x16_bf16 v[16:31], v[104:107], v[80:83], v[16:31]
    ds_read_b128 v[76:79], v7 offset:28672
    s_waitcnt lgkmcnt(12)
    v_mfma_f32_32x32x16_bf16 v[32:47], v[104:107], v[84:87], v[32:47]
    ds_read_b64_tr_b16 v[120:121], v10 offset:40960
    ds_read_b64_tr_b16 v[122:123], v10 offset:41984
    ds_read_b128 v[80:83], v8 offset:24576
    s_waitcnt lgkmcnt(12)
    v_mfma_f32_32x32x16_bf16 v[16:31], v[108:111], v[88:91], v[16:31]
    ds_read_b128 v[84:87], v8 offset:28672
    s_waitcnt lgkmcnt(12)
    v_mfma_f32_32x32x16_bf16 v[32:47], v[108:111], v[92:95], v[32:47]
    ds_read_b64_tr_b16 v[124:125], v10 offset:45056
    ds_read_b64_tr_b16 v[126:127], v10 offset:46080
    ds_read_b128 v[88:91], v9 offset:24576
    s_waitcnt lgkmcnt(12)
    v_mfma_f32_32x32x16_bf16 v[16:31], v[112:115], v[64:67], v[16:31]
    ds_read_b128 v[92:95], v9 offset:28672
    s_waitcnt lgkmcnt(12)
    v_mfma_f32_32x32x16_bf16 v[32:47], v[112:115], v[68:71], v[32:47]
    s_barrier
    v_add_u32 v6, 0xc000, v6
    v_add_u32 v7, 0xc000, v7
    v_add_u32 v8, 0xc000, v8
    v_add_u32 v9, 0xc000, v9
    v_add_u32 v10, 0xc000, v10
    ds_read_b64_tr_b16 v[128:129], v10 offset:8192
    ds_read_b64_tr_b16 v[130:131], v10 offset:9216
    ds_read_b128 v[64:67], v6 offset:0
    s_waitcnt lgkmcnt(12)
    v_mfma_f32_32x32x16_bf16 v[16:31], v[116:119], v[72:75], v[16:31]
    ds_read_b128 v[68:71], v6 offset:4096
    s_waitcnt lgkmcnt(12)
    v_mfma_f32_32x32x16_bf16 v[32:47], v[116:119], v[76:79], v[32:47]
    ds_read_b64_tr_b16 v[132:133], v10 offset:12288
    ds_read_b64_tr_b16 v[134:135], v10 offset:13312
    ds_read_b128 v[72:75], v7 offset:0
    s_waitcnt lgkmcnt(12)
    v_mfma_f32_32x32x16_bf16 v[16:31], v[120:123], v[80:83], v[16:31]
    ds_read_b128 v[76:79], v7 offset:4096
    s_waitcnt lgkmcnt(12)
    v_mfma_f32_32x32x16_bf16 v[32:47], v[120:123], v[84:87], v[32:47]
    ds_read_b64_tr_b16 v[136:137], v10 offset:16384
    ds_read_b64_tr_b16 v[138:139], v10 offset:17408
    ds_read_b128 v[80:83], v8 offset:0
    s_waitcnt lgkmcnt(12)
    v_mfma_f32_32x32x16_bf16 v[16:31], v[124:127], v[88:91], v[16:31]
    ds_read_b128 v[84:87], v8 offset:4096
    s_waitcnt lgkmcnt(12)
    v_mfma_f32_32x32x16_bf16 v[32:47], v[124:127], v[92:95], v[32:47]
    ds_read_b64_tr_b16 v[140:141], v10 offset:20480
    ds_read_b64_tr_b16 v[142:143], v10 offset:21504
    ds_read_b128 v[88:91], v9 offset:0
    s_waitcnt lgkmcnt(12)
    v_mfma_f32_32x32x16_bf16 v[16:31], v[128:131], v[64:67], v[16:31]
    ds_read_b128 v[92:95], v9 offset:4096
    s_waitcnt lgkmcnt(12)
    v_mfma_f32_32x32x16_bf16 v[32:47], v[128:131], v[68:71], v[32:47]
    s_barrier
    ds_read_b64_tr_b16 v[144:145], v10 offset:32768
    ds_read_b64_tr_b16 v[146:147], v10 offset:33792
    ds_read_b128 v[64:67], v6 offset:24576
    s_waitcnt lgkmcnt(12)
    v_mfma_f32_32x32x16_bf16 v[16:31], v[132:135], v[72:75], v[16:31]
    ds_read_b128 v[68:71], v6 offset:28672
    s_waitcnt lgkmcnt(12)
    v_mfma_f32_32x32x16_bf16 v[32:47], v[132:135], v[76:79], v[32:47]
    ds_read_b64_tr_b16 v[148:149], v10 offset:36864
    ds_read_b64_tr_b16 v[150:151], v10 offset:37888
    ds_read_b128 v[72:75], v7 offset:24576
    s_waitcnt lgkmcnt(12)
    v_mfma_f32_32x32x16_bf16 v[16:31], v[136:139], v[80:83], v[16:31]
    ds_read_b128 v[76:79], v7 offset:28672
    s_waitcnt lgkmcnt(12)
    v_mfma_f32_32x32x16_bf16 v[32:47], v[136:139], v[84:87], v[32:47]
    ds_read_b64_tr_b16 v[152:153], v10 offset:40960
    ds_read_b64_tr_b16 v[154:155], v10 offset:41984
    ds_read_b128 v[80:83], v8 offset:24576
    s_waitcnt lgkmcnt(12)
    v_mfma_f32_32x32x16_bf16 v[16:31], v[140:143], v[88:91], v[16:31]
    ds_read_b128 v[84:87], v8 offset:28672
    s_waitcnt lgkmcnt(12)
    v_mfma_f32_32x32x16_bf16 v[32:47], v[140:143], v[92:95], v[32:47]
    ds_read_b64_tr_b16 v[156:157], v10 offset:45056
    ds_read_b64_tr_b16 v[158:159], v10 offset:46080
    ds_read_b128 v[88:91], v9 offset:24576
    s_waitcnt lgkmcnt(12)
    v_mfma_f32_32x32x16_bf16 v[16:31], v[144:147], v[64:67], v[16:31]
    ds_read_b128 v[92:95], v9 offset:28672
    s_waitcnt lgkmcnt(12)
    v_mfma_f32_32x32x16_bf16 v[32:47], v[144:147], v[68:71], v[32:47]
    s_barrier
    v_add_u32 v6, 0xc000, v6
    v_add_u32 v7, 0xc000, v7
    v_add_u32 v8, 0xc000, v8
    v_add_u32 v9, 0xc000, v9
    v_add_u32 v10, 0xc000, v10
    ds_read_b64_tr_b16 v[160:161], v10 offset:8192
    ds_read_b64_tr_b16 v[162:163], v10 offset:9216
    ds_read_b128 v[64:67], v6 offset:0
    s_waitcnt lgkmcnt(12)
    v_mfma_f32_32x32x16_bf16 v[16:31], v[148:151], v[72:75], v[16:31]
    ds_read_b128 v[68:71], v6 offset:4096
    s_waitcnt lgkmcnt(12)
    v_mfma_f32_32x32x16_bf16 v[32:47], v[148:151], v[76:79], v[32:47]
    ds_read_b64_tr_b16 v[164:165], v10 offset:12288
    ds_read_b64_tr_b16 v[166:167], v10 offset:13312
    ds_read_b128 v[72:75], v7 offset:0
    s_waitcnt lgkmcnt(12)
    v_mfma_f32_32x32x16_bf16 v[16:31], v[152:155], v[80:83], v[16:31]
    ds_read_b128 v[76:79], v7 offset:4096
    s_waitcnt lgkmcnt(12)
    v_mfma_f32_32x32x16_bf16 v[32:47], v[152:155], v[84:87], v[32:47]
    ds_read_b64_tr_b16 v[168:169], v10 offset:16384
    ds_read_b64_tr_b16 v[170:171], v10 offset:17408
    ds_read_b128 v[80:83], v8 offset:0
    s_waitcnt lgkmcnt(12)
    v_mfma_f32_32x32x16_bf16 v[16:31], v[156:159], v[88:91], v[16:31]
    ds_read_b128 v[84:87], v8 offset:4096
    s_waitcnt lgkmcnt(12)
    v_mfma_f32_32x32x16_bf16 v[32:47], v[156:159], v[92:95], v[32:47]
    ds_read_b64_tr_b16 v[172:173], v10 offset:20480
    ds_read_b64_tr_b16 v[174:175], v10 offset:21504
    ds_read_b128 v[88:91], v9 offset:0
    s_waitcnt lgkmcnt(12)
    v_mfma_f32_32x32x16_bf16 v[16:31], v[160:163], v[64:67], v[16:31]
    ds_read_b128 v[92:95], v9 offset:4096
    s_waitcnt lgkmcnt(12)
    v_mfma_f32_32x32x16_bf16 v[32:47], v[160:163], v[68:71], v[32:47]
    s_barrier
    ds_read_b64_tr_b16 v[176:177], v10 offset:32768
    ds_read_b64_tr_b16 v[178:179], v10 offset:33792
    ds_read_b128 v[64:67], v6 offset:24576
    s_waitcnt lgkmcnt(12)
    v_mfma_f32_32x32x16_bf16 v[16:31], v[164:167], v[72:75], v[16:31]
    ds_read_b128 v[68:71], v6 offset:28672
    s_waitcnt lgkmcnt(12)
    v_mfma_f32_32x32x16_bf16 v[32:47], v[164:167], v[76:79], v[32:47]
    ds_read_b64_tr_b16 v[180:181], v10 offset:36864
    ds_read_b64_tr_b16 v[182:183], v10 offset:37888
    ds_read_b128 v[72:75], v7 offset:24576
    s_waitcnt lgkmcnt(12)
    v_mfma_f32_32x32x16_bf16 v[16:31], v[168:171], v[80:83], v[16:31]
    ds_read_b128 v[76:79], v7 offset:28672
    s_waitcnt lgkmcnt(12)
    v_mfma_f32_32x32x16_bf16 v[32:47], v[168:171], v[84:87], v[32:47]
    ds_read_b64_tr_b16 v[184:185], v10 offset:40960
    ds_read_b64_tr_b16 v[186:187], v10 offset:41984
    ds_read_b128 v[80:83], v8 offset:24576
    s_waitcnt lgkmcnt(12)
    v_mfma_f32_32x32x16_bf16 v[16:31], v[172:175], v[88:91], v[16:31]
    ds_read_b128 v[84:87], v8 offset:28672
    s_waitcnt lgkmcnt(12)
    v_mfma_f32_32x32x16_bf16 v[32:47], v[172:175], v[92:95], v[32:47]
    ds_read_b64_tr_b16 v[188:189], v10 offset:45056
    ds_read_b64_tr_b16 v[190:191], v10 offset:46080
    ds_read_b128 v[88:91], v9 offset:24576
    s_waitcnt lgkmcnt(12)
    v_mfma_f32_32x32x16_bf16 v[16:31], v[176:179], v[64:67], v[16:31]
    ds_read_b128 v[92:95], v9 offset:28672
    s_waitcnt lgkmcnt(12)
    v_mfma_f32_32x32x16_bf16 v[32:47], v[176:179], v[68:71], v[32:47]
    s_barrier
    v_add_u32 v6, 0xfffe8000, v6
    v_add_u32 v7, 0xfffe8000, v7
    v_add_u32 v8, 0xfffe8000, v8
    v_add_u32 v9, 0xfffe8000, v9
    v_add_u32 v10, 0xfffe8000, v10
    ds_read_b64_tr_b16 v[192:193], v10 offset:8192
    ds_read_b64_tr_b16 v[194:195], v10 offset:9216
    ds_read_b128 v[64:67], v6 offset:0
    s_waitcnt lgkmcnt(12)
    v_mfma_f32_32x32x16_bf16 v[16:31], v[180:183], v[72:75], v[16:31]
    ds_read_b128 v[68:71], v6 offset:4096
    s_waitcnt lgkmcnt(12)
    v_mfma_f32_32x32x16_bf16 v[32:47], v[180:183], v[76:79], v[32:47]
    ds_read_b64_tr_b16 v[196:197], v10 offset:12288
    ds_read_b64_tr_b16 v[198:199], v10 offset:13312
    ds_read_b128 v[72:75], v7 offset:0
    s_waitcnt lgkmcnt(12)
    v_mfma_f32_32x32x16_bf16 v[16:31], v[184:187], v[80:83], v[16:31]
    ds_read_b128 v[76:79], v7 offset:4096
    s_waitcnt lgkmcnt(12)
    v_mfma_f32_32x32x16_bf16 v[32:47], v[184:187], v[84:87], v[32:47]
    ds_read_b64_tr_b16 v[200:201], v10 offset:16384
    ds_read_b64_tr_b16 v[202:203], v10 offset:17408
    ds_read_b128 v[80:83], v8 offset:0
    s_waitcnt lgkmcnt(12)
    v_mfma_f32_32x32x16_bf16 v[16:31], v[188:191], v[88:91], v[16:31]
    ds_read_b128 v[84:87], v8 offset:4096
    s_waitcnt lgkmcnt(12)
    v_mfma_f32_32x32x16_bf16 v[32:47], v[188:191], v[92:95], v[32:47]
    ds_read_b64_tr_b16 v[204:205], v10 offset:20480
    ds_read_b64_tr_b16 v[206:207], v10 offset:21504
    ds_read_b128 v[88:91], v9 offset:0
    s_waitcnt lgkmcnt(12)
    v_mfma_f32_32x32x16_bf16 v[16:31], v[192:195], v[64:67], v[16:31]
    ds_read_b128 v[92:95], v9 offset:4096
    s_waitcnt lgkmcnt(12)
    v_mfma_f32_32x32x16_bf16 v[32:47], v[192:195], v[68:71], v[32:47]
    s_barrier
    ds_read_b64_tr_b16 v[208:209], v10 offset:32768
    ds_read_b64_tr_b16 v[210:211], v10 offset:33792
    ds_read_b128 v[64:67], v6 offset:24576
    s_waitcnt lgkmcnt(12)
    v_mfma_f32_32x32x16_bf16 v[16:31], v[196:199], v[72:75], v[16:31]
    ds_read_b128 v[68:71], v6 offset:28672
    s_waitcnt lgkmcnt(12)
    v_mfma_f32_32x32x16_bf16 v[32:47], v[196:199], v[76:79], v[32:47]
    ds_read_b64_tr_b16 v[212:213], v10 offset:36864
    ds_read_b64_tr_b16 v[214:215], v10 offset:37888
    ds_read_b128 v[72:75], v7 offset:24576
    s_waitcnt lgkmcnt(12)
    v_mfma_f32_32x32x16_bf16 v[16:31], v[200:203], v[80:83], v[16:31]
    ds_read_b128 v[76:79], v7 offset:28672
    s_waitcnt lgkmcnt(12)
    v_mfma_f32_32x32x16_bf16 v[32:47], v[200:203], v[84:87], v[32:47]
    ds_read_b64_tr_b16 v[216:217], v10 offset:40960
    ds_read_b64_tr_b16 v[218:219], v10 offset:41984
    ds_read_b128 v[80:83], v8 offset:24576
    s_waitcnt lgkmcnt(12)
    v_mfma_f32_32x32x16_bf16 v[16:31], v[204:207], v[88:91], v[16:31]
    ds_read_b128 v[84:87], v8 offset:28672
    s_waitcnt lgkmcnt(12)
    v_mfma_f32_32x32x16_bf16 v[32:47], v[204:207], v[92:95], v[32:47]
    ds_read_b64_tr_b16 v[220:221], v10 offset:45056
    ds_read_b64_tr_b16 v[222:223], v10 offset:46080
    ds_read_b128 v[88:91], v9 offset:24576
    s_waitcnt lgkmcnt(12)
    v_mfma_f32_32x32x16_bf16 v[16:31], v[208:211], v[64:67], v[16:31]
    ds_read_b128 v[92:95], v9 offset:28672
    s_waitcnt lgkmcnt(12)
    v_mfma_f32_32x32x16_bf16 v[32:47], v[208:211], v[68:71], v[32:47]
    s_barrier
    v_add_u32 v6, 0xc000, v6
    v_add_u32 v7, 0xc000, v7
    v_add_u32 v8, 0xc000, v8
    v_add_u32 v9, 0xc000, v9
    v_add_u32 v10, 0xc000, v10
    ds_read_b64_tr_b16 v[224:225], v10 offset:8192
    ds_read_b64_tr_b16 v[226:227], v10 offset:9216
    ds_read_b128 v[64:67], v6 offset:0
    s_waitcnt lgkmcnt(12)
    v_mfma_f32_32x32x16_bf16 v[16:31], v[212:215], v[72:75], v[16:31]
    ds_read_b128 v[68:71], v6 offset:4096
    s_waitcnt lgkmcnt(12)
    v_mfma_f32_32x32x16_bf16 v[32:47], v[212:215], v[76:79], v[32:47]
    ds_read_b64_tr_b16 v[228:229], v10 offset:12288
    ds_read_b64_tr_b16 v[230:231], v10 offset:13312
    ds_read_b128 v[72:75], v7 offset:0
    s_waitcnt lgkmcnt(12)
    v_mfma_f32_32x32x16_bf16 v[16:31], v[216:219], v[80:83], v[16:31]
    ds_read_b128 v[76:79], v7 offset:4096
    s_waitcnt lgkmcnt(12)
    v_mfma_f32_32x32x16_bf16 v[32:47], v[216:219], v[84:87], v[32:47]
    ds_read_b64_tr_b16 v[232:233], v10 offset:16384
    ds_read_b64_tr_b16 v[234:235], v10 offset:17408
    ds_read_b128 v[80:83], v8 offset:0
    s_waitcnt lgkmcnt(12)
    v_mfma_f32_32x32x16_bf16 v[16:31], v[220:223], v[88:91], v[16:31]
    ds_read_b128 v[84:87], v8 offset:4096
    s_waitcnt lgkmcnt(12)
    v_mfma_f32_32x32x16_bf16 v[32:47], v[220:223], v[92:95], v[32:47]
    ds_read_b64_tr_b16 v[236:237], v10 offset:20480
    ds_read_b64_tr_b16 v[238:239], v10 offset:21504
    ds_read_b128 v[88:91], v9 offset:0
    s_waitcnt lgkmcnt(12)
    v_mfma_f32_32x32x16_bf16 v[16:31], v[224:227], v[64:67], v[16:31]
    ds_read_b128 v[92:95], v9 offset:4096
    s_waitcnt lgkmcnt(12)
    v_mfma_f32_32x32x16_bf16 v[32:47], v[224:227], v[68:71], v[32:47]
    s_barrier
    ds_read_b64_tr_b16 v[240:241], v10 offset:32768
    ds_read_b64_tr_b16 v[242:243], v10 offset:33792
    ds_read_b128 v[64:67], v6 offset:24576
    s_waitcnt lgkmcnt(12)
    v_mfma_f32_32x32x16_bf16 v[16:31], v[228:231], v[72:75], v[16:31]
    ds_read_b128 v[68:71], v6 offset:28672
    s_waitcnt lgkmcnt(12)
    v_mfma_f32_32x32x16_bf16 v[32:47], v[228:231], v[76:79], v[32:47]
    ds_read_b64_tr_b16 v[244:245], v10 offset:36864
    ds_read_b64_tr_b16 v[246:247], v10 offset:37888
    ds_read_b128 v[72:75], v7 offset:24576
    s_waitcnt lgkmcnt(12)
    v_mfma_f32_32x32x16_bf16 v[16:31], v[232:235], v[80:83], v[16:31]
    ds_read_b128 v[76:79], v7 offset:28672
    s_waitcnt lgkmcnt(12)
    v_mfma_f32_32x32x16_bf16 v[32:47], v[232:235], v[84:87], v[32:47]
    ds_read_b64_tr_b16 v[248:249], v10 offset:40960
    ds_read_b64_tr_b16 v[250:251], v10 offset:41984
    ds_read_b128 v[80:83], v8 offset:24576
    s_waitcnt lgkmcnt(12)
    v_mfma_f32_32x32x16_bf16 v[16:31], v[236:239], v[88:91], v[16:31]
    ds_read_b128 v[84:87], v8 offset:28672
    s_waitcnt lgkmcnt(12)
    v_mfma_f32_32x32x16_bf16 v[32:47], v[236:239], v[92:95], v[32:47]
    ds_read_b64_tr_b16 v[252:253], v10 offset:45056
    ds_read_b64_tr_b16 v[254:255], v10 offset:46080
    ds_read_b128 v[88:91], v9 offset:24576
    s_waitcnt lgkmcnt(12)
    v_mfma_f32_32x32x16_bf16 v[16:31], v[240:243], v[64:67], v[16:31]
    ds_read_b128 v[92:95], v9 offset:28672
    s_waitcnt lgkmcnt(12)
    v_mfma_f32_32x32x16_bf16 v[32:47], v[240:243], v[68:71], v[32:47]
    s_barrier
    v_add_u32 v6, 0xc000, v6
    v_add_u32 v7, 0xc000, v7
    v_add_u32 v8, 0xc000, v8
    v_add_u32 v9, 0xc000, v9
    ds_read_b128 v[64:67], v6 offset:0
    s_waitcnt lgkmcnt(10)
    v_mfma_f32_32x32x16_bf16 v[16:31], v[244:247], v[72:75], v[16:31]
    ds_read_b128 v[68:71], v7 offset:0
    s_waitcnt lgkmcnt(10)
    v_mfma_f32_32x32x16_bf16 v[32:47], v[244:247], v[76:79], v[32:47]
    ds_read_b128 v[72:75], v8 offset:0
    s_waitcnt lgkmcnt(8)
    v_mfma_f32_32x32x16_bf16 v[16:31], v[248:251], v[80:83], v[16:31]
    ds_read_b128 v[76:79], v9 offset:0
    s_waitcnt lgkmcnt(8)
    v_mfma_f32_32x32x16_bf16 v[32:47], v[248:251], v[84:87], v[32:47]
    ds_read_b128 v[80:83], v6 offset:4096
    s_waitcnt lgkmcnt(6)
    v_mfma_f32_32x32x16_bf16 v[16:31], v[252:255], v[88:91], v[16:31]
    ds_read_b128 v[84:87], v7 offset:4096
    s_waitcnt lgkmcnt(6)
    v_mfma_f32_32x32x16_bf16 v[32:47], v[252:255], v[92:95], v[32:47]
    ds_read_b128 v[88:91], v8 offset:4096
    s_waitcnt lgkmcnt(6)
    v_mfma_f32_32x32x16_bf16 v[48:63], v[96:99], v[64:67], 0
    ds_read_b128 v[92:95], v9 offset:4096
    s_waitcnt lgkmcnt(6)
    v_mfma_f32_32x32x16_bf16 v[48:63], v[100:103], v[68:71], v[48:63]
    ds_read_b128 v[64:67], v6 offset:8192
    v_cvt_pk_bf16_f32 v16, v16, v17
    v_cvt_pk_bf16_f32 v17, v18, v19
    v_cvt_pk_bf16_f32 v18, v20, v21
    v_cvt_pk_bf16_f32 v19, v22, v23
    s_waitcnt lgkmcnt(6)
    v_mfma_f32_32x32x16_bf16 v[48:63], v[104:107], v[72:75], v[48:63]
    ds_read_b128 v[68:71], v7 offset:8192
    buffer_store_dwordx4 v[16:19], v5, s[24:27], s50 offen offset:0 sc1
    s_waitcnt lgkmcnt(6)
    v_mfma_f32_32x32x16_bf16 v[48:63], v[108:111], v[76:79], v[48:63]
    ds_read_b128 v[72:75], v8 offset:8192
    v_cvt_pk_bf16_f32 v24, v24, v25
    v_cvt_pk_bf16_f32 v25, v26, v27
    v_cvt_pk_bf16_f32 v26, v28, v29
    v_cvt_pk_bf16_f32 v27, v30, v31
    s_waitcnt lgkmcnt(6)
    v_mfma_f32_32x32x16_bf16 v[48:63], v[112:115], v[80:83], v[48:63]
    ds_read_b128 v[76:79], v9 offset:8192
    buffer_store_dwordx4 v[24:27], v5, s[24:27], s50 offen offset:1024 sc1
    s_add_u32 s50, s50, 40960
    s_waitcnt lgkmcnt(6)
    v_mfma_f32_32x32x16_bf16 v[48:63], v[116:119], v[84:87], v[48:63]
    ds_read_b128 v[80:83], v6 offset:12288
    v_cvt_pk_bf16_f32 v32, v32, v33
    v_cvt_pk_bf16_f32 v33, v34, v35
    v_cvt_pk_bf16_f32 v34, v36, v37
    v_cvt_pk_bf16_f32 v35, v38, v39
    s_waitcnt lgkmcnt(6)
    v_mfma_f32_32x32x16_bf16 v[48:63], v[120:123], v[88:91], v[48:63]
    ds_read_b128 v[84:87], v7 offset:12288
    buffer_store_dwordx4 v[32:35], v5, s[24:27], s50 offen offset:0 sc1
    s_waitcnt lgkmcnt(6)
    v_mfma_f32_32x32x16_bf16 v[48:63], v[124:127], v[92:95], v[48:63]
    ds_read_b128 v[88:91], v8 offset:12288
    v_cvt_pk_bf16_f32 v40, v40, v41
    v_cvt_pk_bf16_f32 v41, v42, v43
    v_cvt_pk_bf16_f32 v42, v44, v45
    v_cvt_pk_bf16_f32 v43, v46, v47
    s_waitcnt lgkmcnt(6)
    v_mfma_f32_32x32x16_bf16 v[48:63], v[128:131], v[64:67], v[48:63]
    ds_read_b128 v[92:95], v9 offset:12288
    buffer_store_dwordx4 v[40:43], v5, s[24:27], s50 offen offset:1024 sc1
    s_add_u32 s50, s50, 40960
    s_waitcnt lgkmcnt(6)
    v_mfma_f32_32x32x16_bf16 v[48:63], v[132:135], v[68:71], v[48:63]
    ds_read_b128 v[64:67], v6 offset:16384
    s_waitcnt lgkmcnt(6)
    v_mfma_f32_32x32x16_bf16 v[48:63], v[136:139], v[72:75], v[48:63]
    ds_read_b128 v[68:71], v7 offset:16384
    s_waitcnt lgkmcnt(6)
    v_mfma_f32_32x32x16_bf16 v[48:63], v[140:143], v[76:79], v[48:63]
    ds_read_b128 v[72:75], v8 offset:16384
    s_waitcnt lgkmcnt(6)
    v_mfma_f32_32x32x16_bf16 v[48:63], v[144:147], v[80:83], v[48:63]
    ds_read_b128 v[76:79], v9 offset:16384
    s_waitcnt lgkmcnt(6)
    v_mfma_f32_32x32x16_bf16 v[48:63], v[148:151], v[84:87], v[48:63]
    s_barrier
    ds_read_b128 v[80:83], v6 offset:24576
    s_waitcnt lgkmcnt(6)
    v_mfma_f32_32x32x16_bf16 v[48:63], v[152:155], v[88:91], v[48:63]
    ds_read_b128 v[84:87], v7 offset:24576
    s_waitcnt lgkmcnt(6)
    v_mfma_f32_32x32x16_bf16 v[48:63], v[156:159], v[92:95], v[48:63]
    ds_read_b128 v[88:91], v8 offset:24576
    s_waitcnt lgkmcnt(6)
    v_mfma_f32_32x32x16_bf16 v[48:63], v[160:163], v[64:67], v[48:63]
    ds_read_b128 v[92:95], v9 offset:24576
    s_waitcnt lgkmcnt(6)
    v_mfma_f32_32x32x16_bf16 v[48:63], v[164:167], v[68:71], v[48:63]
    ds_read_b128 v[64:67], v6 offset:28672
    s_waitcnt lgkmcnt(6)
    v_mfma_f32_32x32x16_bf16 v[48:63], v[168:171], v[72:75], v[48:63]
    ds_read_b128 v[68:71], v7 offset:28672
    s_waitcnt lgkmcnt(6)
    v_mfma_f32_32x32x16_bf16 v[48:63], v[172:175], v[76:79], v[48:63]
    ds_read_b128 v[72:75], v8 offset:28672
    s_waitcnt lgkmcnt(6)
    v_mfma_f32_32x32x16_bf16 v[48:63], v[176:179], v[80:83], v[48:63]
    ds_read_b128 v[76:79], v9 offset:28672
    s_waitcnt lgkmcnt(6)
    v_mfma_f32_32x32x16_bf16 v[48:63], v[180:183], v[84:87], v[48:63]
    ds_read_b128 v[80:83], v6 offset:32768
    s_waitcnt lgkmcnt(6)
    v_mfma_f32_32x32x16_bf16 v[48:63], v[184:187], v[88:91], v[48:63]
    ds_read_b128 v[84:87], v7 offset:32768
    s_waitcnt lgkmcnt(6)
    v_mfma_f32_32x32x16_bf16 v[48:63], v[188:191], v[92:95], v[48:63]
    ds_read_b128 v[88:91], v8 offset:32768
    s_waitcnt lgkmcnt(6)
    v_mfma_f32_32x32x16_bf16 v[48:63], v[192:195], v[64:67], v[48:63]
    ds_read_b128 v[92:95], v9 offset:32768
    s_waitcnt lgkmcnt(6)
    v_mfma_f32_32x32x16_bf16 v[48:63], v[196:199], v[68:71], v[48:63]
    ds_read_b128 v[64:67], v6 offset:36864
    s_waitcnt lgkmcnt(6)
    v_mfma_f32_32x32x16_bf16 v[48:63], v[200:203], v[72:75], v[48:63]
    ds_read_b128 v[68:71], v7 offset:36864
    s_waitcnt lgkmcnt(6)
    v_mfma_f32_32x32x16_bf16 v[48:63], v[204:207], v[76:79], v[48:63]
    ds_read_b128 v[72:75], v8 offset:36864
    s_waitcnt lgkmcnt(6)
    v_mfma_f32_32x32x16_bf16 v[48:63], v[208:211], v[80:83], v[48:63]
    ds_read_b128 v[76:79], v9 offset:36864
    s_waitcnt lgkmcnt(6)
    v_mfma_f32_32x32x16_bf16 v[48:63], v[212:215], v[84:87], v[48:63]
    ds_read_b128 v[80:83], v6 offset:40960
    s_waitcnt lgkmcnt(6)
    v_mfma_f32_32x32x16_bf16 v[48:63], v[216:219], v[88:91], v[48:63]
    ds_read_b128 v[84:87], v7 offset:40960
    s_waitcnt lgkmcnt(6)
    v_mfma_f32_32x32x16_bf16 v[48:63], v[220:223], v[92:95], v[48:63]
    ds_read_b128 v[88:91], v8 offset:40960
    s_waitcnt lgkmcnt(6)
    v_mfma_f32_32x32x16_bf16 v[48:63], v[224:227], v[64:67], v[48:63]
    ds_read_b128 v[92:95], v9 offset:40960
    s_waitcnt lgkmcnt(6)
    v_mfma_f32_32x32x16_bf16 v[48:63], v[228:231], v[68:71], v[48:63]
    s_barrier
    v_add_u32 v6, 0xfffe8000, v6
    v_add_u32 v7, 0xfffe8000, v7
    v_add_u32 v8, 0xfffe8000, v8
    v_add_u32 v9, 0xfffe8000, v9
    ds_read_b128 v[64:67], v6 offset:0
    s_waitcnt lgkmcnt(6)
    v_mfma_f32_32x32x16_bf16 v[48:63], v[232:235], v[72:75], v[48:63]
    ds_read_b128 v[68:71], v7 offset:0
    s_waitcnt lgkmcnt(6)
    v_mfma_f32_32x32x16_bf16 v[48:63], v[236:239], v[76:79], v[48:63]
    ds_read_b128 v[72:75], v8 offset:0
    s_waitcnt lgkmcnt(6)
    v_mfma_f32_32x32x16_bf16 v[48:63], v[240:243], v[80:83], v[48:63]
    ds_read_b128 v[76:79], v9 offset:0
    s_waitcnt lgkmcnt(6)
    v_mfma_f32_32x32x16_bf16 v[48:63], v[244:247], v[84:87], v[48:63]
    ds_read_b128 v[80:83], v6 offset:4096
    s_waitcnt lgkmcnt(6)
    v_mfma_f32_32x32x16_bf16 v[48:63], v[248:251], v[88:91], v[48:63]
    ds_read_b128 v[84:87], v7 offset:4096
    s_waitcnt lgkmcnt(6)
    v_mfma_f32_32x32x16_bf16 v[48:63], v[252:255], v[92:95], v[48:63]
    ds_read_b128 v[88:91], v8 offset:4096
    s_waitcnt lgkmcnt(6)
    v_mfma_f32_32x32x16_bf16 v[16:31], v[96:99], v[64:67], 0
    ds_read_b128 v[92:95], v9 offset:4096
    s_waitcnt lgkmcnt(6)
    v_mfma_f32_32x32x16_bf16 v[16:31], v[100:103], v[68:71], v[16:31]
    ds_read_b128 v[64:67], v6 offset:8192
    v_cvt_pk_bf16_f32 v48, v48, v49
    v_cvt_pk_bf16_f32 v49, v50, v51
    v_cvt_pk_bf16_f32 v50, v52, v53
    v_cvt_pk_bf16_f32 v51, v54, v55
    s_waitcnt lgkmcnt(6)
    v_mfma_f32_32x32x16_bf16 v[16:31], v[104:107], v[72:75], v[16:31]
    ds_read_b128 v[68:71], v7 offset:8192
    buffer_store_dwordx4 v[48:51], v5, s[24:27], s50 offen offset:0 sc1
    s_waitcnt lgkmcnt(6)
    v_mfma_f32_32x32x16_bf16 v[16:31], v[108:111], v[76:79], v[16:31]
    ds_read_b128 v[72:75], v8 offset:8192
    v_cvt_pk_bf16_f32 v56, v56, v57
    v_cvt_pk_bf16_f32 v57, v58, v59
    v_cvt_pk_bf16_f32 v58, v60, v61
    v_cvt_pk_bf16_f32 v59, v62, v63
    s_waitcnt vmcnt(1)
    s_mov_b64 exec, 0xffff
    buffer_atomic_add v2, v3, s[24:27], s51 offen offset:0 sc1
    s_mov_b64 exec, -1
    s_waitcnt lgkmcnt(6)
    v_mfma_f32_32x32x16_bf16 v[16:31], v[112:115], v[80:83], v[16:31]
    ds_read_b128 v[76:79], v9 offset:8192
    buffer_store_dwordx4 v[56:59], v5, s[24:27], s50 offen offset:1024 sc1
    s_add_u32 s50, s50, 40960
    s_waitcnt lgkmcnt(6)
    v_mfma_f32_32x32x16_bf16 v[16:31], v[116:119], v[84:87], v[16:31]
    ds_read_b128 v[80:83], v6 offset:12288
    s_waitcnt lgkmcnt(6)
    v_mfma_f32_32x32x16_bf16 v[16:31], v[120:123], v[88:91], v[16:31]
    ds_read_b128 v[84:87], v7 offset:12288
    s_waitcnt lgkmcnt(6)
    v_mfma_f32_32x32x16_bf16 v[16:31], v[124:127], v[92:95], v[16:31]
    ds_read_b128 v[88:91], v8 offset:12288
    s_waitcnt lgkmcnt(6)
    v_mfma_f32_32x32x16_bf16 v[16:31], v[128:131], v[64:67], v[16:31]
    ds_read_b128 v[92:95], v9 offset:12288
    s_waitcnt lgkmcnt(6)
    v_mfma_f32_32x32x16_bf16 v[16:31], v[132:135], v[68:71], v[16:31]
    ds_read_b128 v[64:67], v6 offset:16384
    s_waitcnt lgkmcnt(6)
    v_mfma_f32_32x32x16_bf16 v[16:31], v[136:139], v[72:75], v[16:31]
    ds_read_b128 v[68:71], v7 offset:16384
    s_waitcnt lgkmcnt(6)
    v_mfma_f32_32x32x16_bf16 v[16:31], v[140:143], v[76:79], v[16:31]
    ds_read_b128 v[72:75], v8 offset:16384
    s_waitcnt lgkmcnt(6)
    v_mfma_f32_32x32x16_bf16 v[16:31], v[144:147], v[80:83], v[16:31]
    ds_read_b128 v[76:79], v9 offset:16384
    s_waitcnt lgkmcnt(6)
    v_mfma_f32_32x32x16_bf16 v[16:31], v[148:151], v[84:87], v[16:31]
    s_barrier
    ds_read_b128 v[80:83], v6 offset:24576
    s_waitcnt lgkmcnt(6)
    v_mfma_f32_32x32x16_bf16 v[16:31], v[152:155], v[88:91], v[16:31]
    ds_read_b128 v[84:87], v7 offset:24576
    s_waitcnt lgkmcnt(6)
    v_mfma_f32_32x32x16_bf16 v[16:31], v[156:159], v[92:95], v[16:31]
    ds_read_b128 v[88:91], v8 offset:24576
    s_waitcnt lgkmcnt(6)
    v_mfma_f32_32x32x16_bf16 v[16:31], v[160:163], v[64:67], v[16:31]
    ds_read_b128 v[92:95], v9 offset:24576
    s_waitcnt lgkmcnt(6)
    v_mfma_f32_32x32x16_bf16 v[16:31], v[164:167], v[68:71], v[16:31]
    ds_read_b128 v[64:67], v6 offset:28672
    s_waitcnt lgkmcnt(6)
    v_mfma_f32_32x32x16_bf16 v[16:31], v[168:171], v[72:75], v[16:31]
    ds_read_b128 v[68:71], v7 offset:28672
    s_waitcnt lgkmcnt(6)
    v_mfma_f32_32x32x16_bf16 v[16:31], v[172:175], v[76:79], v[16:31]
    ds_read_b128 v[72:75], v8 offset:28672
    s_waitcnt lgkmcnt(6)
    v_mfma_f32_32x32x16_bf16 v[16:31], v[176:179], v[80:83], v[16:31]
    ds_read_b128 v[76:79], v9 offset:28672
    s_waitcnt lgkmcnt(6)
    v_mfma_f32_32x32x16_bf16 v[16:31], v[180:183], v[84:87], v[16:31]
    ds_read_b128 v[80:83], v6 offset:32768
    s_waitcnt lgkmcnt(6)
    v_mfma_f32_32x32x16_bf16 v[16:31], v[184:187], v[88:91], v[16:31]
    ds_read_b128 v[84:87], v7 offset:32768
    s_waitcnt lgkmcnt(6)
    v_mfma_f32_32x32x16_bf16 v[16:31], v[188:191], v[92:95], v[16:31]
    ds_read_b128 v[88:91], v8 offset:32768
    s_waitcnt lgkmcnt(6)
    v_mfma_f32_32x32x16_bf16 v[16:31], v[192:195], v[64:67], v[16:31]
    ds_read_b128 v[92:95], v9 offset:32768
    s_waitcnt lgkmcnt(6)
    v_mfma_f32_32x32x16_bf16 v[16:31], v[196:199], v[68:71], v[16:31]
    ds_read_b128 v[64:67], v6 offset:36864
    s_waitcnt lgkmcnt(6)
    v_mfma_f32_32x32x16_bf16 v[16:31], v[200:203], v[72:75], v[16:31]
    ds_read_b128 v[68:71], v7 offset:36864
    s_waitcnt lgkmcnt(6)
    v_mfma_f32_32x32x16_bf16 v[16:31], v[204:207], v[76:79], v[16:31]
    ds_read_b128 v[72:75], v8 offset:36864
    s_waitcnt lgkmcnt(6)
    v_mfma_f32_32x32x16_bf16 v[16:31], v[208:211], v[80:83], v[16:31]
    ds_read_b128 v[76:79], v9 offset:36864
    s_waitcnt lgkmcnt(6)
    v_mfma_f32_32x32x16_bf16 v[16:31], v[212:215], v[84:87], v[16:31]
    ds_read_b128 v[80:83], v6 offset:40960
    s_waitcnt lgkmcnt(6)
    v_mfma_f32_32x32x16_bf16 v[16:31], v[216:219], v[88:91], v[16:31]
    ds_read_b128 v[84:87], v7 offset:40960
    s_waitcnt lgkmcnt(6)
    v_mfma_f32_32x32x16_bf16 v[16:31], v[220:223], v[92:95], v[16:31]
    ds_read_b128 v[88:91], v8 offset:40960
    s_waitcnt lgkmcnt(6)
    v_mfma_f32_32x32x16_bf16 v[16:31], v[224:227], v[64:67], v[16:31]
    ds_read_b128 v[92:95], v9 offset:40960
    s_waitcnt lgkmcnt(6)
    v_mfma_f32_32x32x16_bf16 v[16:31], v[228:231], v[68:71], v[16:31]
    s_waitcnt lgkmcnt(5)
    v_mfma_f32_32x32x16_bf16 v[16:31], v[232:235], v[72:75], v[16:31]
    s_waitcnt lgkmcnt(4)
    v_mfma_f32_32x32x16_bf16 v[16:31], v[236:239], v[76:79], v[16:31]
    s_waitcnt vmcnt(0)
    s_mov_b64 exec, 0xffff
    buffer_atomic_add v2, v3, s[24:27], s51 offen offset:32 sc1
    s_mov_b64 exec, -1
    s_waitcnt lgkmcnt(3)
    v_mfma_f32_32x32x16_bf16 v[16:31], v[240:243], v[80:83], v[16:31]
    s_waitcnt lgkmcnt(2)
    v_mfma_f32_32x32x16_bf16 v[16:31], v[244:247], v[84:87], v[16:31]
    s_waitcnt lgkmcnt(1)
    v_mfma_f32_32x32x16_bf16 v[16:31], v[248:251], v[88:91], v[16:31]
    s_waitcnt lgkmcnt(0)
    v_mfma_f32_32x32x16_bf16 v[16:31], v[252:255], v[92:95], v[16:31]
    s_nop 15
    v_cvt_pk_bf16_f32 v16, v16, v17
    v_cvt_pk_bf16_f32 v17, v18, v19
    v_cvt_pk_bf16_f32 v18, v20, v21
    v_cvt_pk_bf16_f32 v19, v22, v23
    buffer_store_dwordx4 v[16:19], v5, s[24:27], s50 offen offset:0 sc1
    v_cvt_pk_bf16_f32 v24, v24, v25
    v_cvt_pk_bf16_f32 v25, v26, v27
    v_cvt_pk_bf16_f32 v26, v28, v29
    v_cvt_pk_bf16_f32 v27, v30, v31
    buffer_store_dwordx4 v[24:27], v5, s[24:27], s50 offen offset:1024 sc1
    s_add_u32 s50, s50, 40960
    s_barrier
    s_waitcnt vmcnt(0)
    s_mov_b64 exec, 0xffff
    buffer_atomic_add v2, v3, s[24:27], s51 offen offset:64 sc1
    s_mov_b64 exec, -1
    s_branch P2_LD
XRM_END:
P2_PUB:
    v_mov_b32 v2, 1
    v_lshlrev_b32 v3, s53, v1
    s_waitcnt vmcnt(0)
    s_mov_b64 exec, 0xffff
    buffer_atomic_add v2, v3, s[24:27], s51 offen sc1
    s_mov_b64 exec, 1
    ds_add_u32 v4, v2 offset:8
    s_mov_b64 exec, -1
P2_LD:
    s_and_b32 s38, s37, 3
    s_lshl_b32 s38, s38, 2
    s_and_b32 s39, s3, 3
    s_add_u32 s38, s38, s39
    s_lshr_b32 s39, s37, 2
    s_lshl_b32 s39, s39, 3
    s_lshr_b32 s4, s3, 2
    s_add_u32 s39, s39, s4
    s_lshl_b32 s45, s38, 4
    s_add_u32 s45, s45, s39
    s_lshl_b32 s45, s45, 7
    s_add_u32 s44, s45, 4620288
    s_add_u32 s45, s45, 4587520
    s_max_u32 s4, s36, 5
    s_mul_i32 s4, s4, 32
    s_add_u32 s44, s44, s4
    s_sub_u32 s44, s44, 160
    s_lshl2_add_u32 s19, s38, s36
    s_mul_i32 s19, s19, 40960
    s_mul_i32 s18, s36, 12288
    v_lshlrev_b32 v6, 4, v1
    s_mul_i32 s22, s39, 122880
    s_add_u32 s22, s22, 2621440
    s_lshl_b32 s21, s36, 10
    s_add_u32 s22, s22, s21
    v_bfe_u32 v2, v1, 2, 2
    v_bfe_u32 v3, v1, 4, 1
    v_and_b32 v5, 0x23, v1
    v_lshl_add_u32 v5, v2, 3, v5
    v_lshl_add_u32 v5, v3, 2, v5
    v_lshlrev_b32 v5, 4, v5
    v_lshlrev_b32 v2, 7, v1
    v_mov_b32 v4, 155648
    s_cmp_lg_u32 s36, 0
    s_cbranch_scc1 P2_LW0
    s_mov_b32 s7, 40000
P2_W:
    s_sub_u32 s7, s7, 1
    s_cbranch_scc1 P2_W_X
    s_buffer_load_dword s61, s[24:27], s45 glc
P2_W_C:
    s_waitcnt lgkmcnt(0)
    s_cmp_lt_u32 s61, 42
    s_cbranch_scc1 P2_W
P2_W_X:
    v_mov_b32 v3, 1
    ds_write_b32 v4, v3 offset:4
    s_branch P2_GO
P2_LW0:
    s_branch P2_LW
P2_LW_S:
    s_sleep 1
P2_LW:
    ds_read_b32 v3, v4 offset:4
    s_waitcnt lgkmcnt(0)
    v_cmp_ne_u32 vcc, 0, v3
    s_cmp_eq_u64 vcc, -1
    s_cbranch_scc0 P2_LW_S
P2_GO:
    s_add_u32 s5, s22, 0
    s_add_u32 m0, s21, 0
    s_nop 0
    buffer_load_dwordx4 v5, s[24:27], s5 offen sc1 lds
    s_add_u32 s5, s22, 40960
    s_add_u32 m0, s21, 40960
    s_nop 0
    buffer_load_dwordx4 v5, s[24:27], s5 offen sc1 lds
    s_add_u32 s5, s22, 4096
    s_add_u32 m0, s21, 4096
    s_nop 0
    buffer_load_dwordx4 v5, s[24:27], s5 offen sc1 lds
    s_add_u32 s5, s22, 45056
    s_add_u32 m0, s21, 45056
    s_nop 0
    buffer_load_dwordx4 v5, s[24:27], s5 offen sc1 lds
    s_add_u32 s5, s22, 8192
    s_add_u32 m0, s21, 8192
    s_nop 0
    buffer_load_dwordx4 v5, s[24:27], s5 offen sc1 lds
    s_add_u32 s5, s22, 49152
    s_add_u32 m0, s21, 49152
    s_nop 0
    buffer_load_dwordx4 v5, s[24:27], s5 offen sc1 lds
    s_add_u32 s5, s22, 12288
    s_add_u32 m0, s21, 12288
    s_nop 0
    buffer_load_dwordx4 v5, s[24:27], s5 offen sc1 lds
    s_add_u32 s5, s22, 53248
    s_add_u32 m0, s21, 53248
    s_nop 0
    buffer_load_dwordx4 v5, s[24:27], s5 offen sc1 lds
    s_waitcnt vmcnt(6)
    s_barrier
    s_add_u32 s5, s22, 16384
    s_add_u32 m0, s21, 16384
    s_nop 0
    buffer_load_dwordx4 v5, s[24:27], s5 offen sc1 lds
    s_add_u32 s5, s22, 57344
    s_add_u32 m0, s21, 57344
    s_nop 0
    buffer_load_dwordx4 v5, s[24:27], s5 offen sc1 lds
    s_add_u32 s5, s22, 20480
    s_add_u32 m0, s21, 20480
    s_nop 0
    buffer_load_dwordx4 v5, s[24:27], s5 offen sc1 lds
    s_add_u32 s5, s22, 61440
    s_add_u32 m0, s21, 61440
    s_nop 0
    buffer_load_dwordx4 v5, s[24:27], s5 offen sc1 lds
    s_waitcnt vmcnt(8)
    s_barrier
    s_add_u32 s5, s22, 24576
    s_add_u32 m0, s21, 24576
    s_nop 0
    buffer_load_dwordx4 v5, s[24:27], s5 offen sc1 lds
    s_add_u32 s5, s22, 65536
    s_add_u32 m0, s21, 65536
    s_nop 0
    buffer_load_dwordx4 v5, s[24:27], s5 offen sc1 lds
    s_add_u32 s5, s19, 28672
    s_add_u32 m0, s18, 106496
    s_nop 0
    buffer_load_dwordx4 v6, s[24:27], s5 offen sc1 lds
    s_add_u32 s5, s19, 29696
    s_add_u32 m0, s18, 107520
    s_nop 0
    buffer_load_dwordx4 v6, s[24:27], s5 offen sc1 lds
    s_waitcnt vmcnt(8)
    s_barrier
    s_add_u32 s5, s19, 30720
    s_add_u32 m0, s18, 108544
    s_nop 0
    buffer_load_dwordx4 v6, s[24:27], s5 offen sc1 lds
    s_add_u32 s5, s19, 31744
    s_add_u32 m0, s18, 109568
    s_nop 0
    buffer_load_dwordx4 v6, s[24:27], s5 offen sc1 lds
    s_add_u32 s5, s22, 28672
    s_add_u32 m0, s21, 28672
    s_nop 0
    buffer_load_dwordx4 v5, s[24:27], s5 offen sc1 lds
    s_add_u32 s5, s22, 69632
    s_add_u32 m0, s21, 69632
    s_nop 0
    buffer_load_dwordx4 v5, s[24:27], s5 offen sc1 lds
    s_add_u32 s5, s19, 32768
    s_add_u32 m0, s18, 110592
    s_nop 0
    buffer_load_dwordx4 v6, s[24:27], s5 offen sc1 lds
    s_add_u32 s5, s19, 33792
    s_add_u32 m0, s18, 111616
    s_nop 0
    buffer_load_dwordx4 v6, s[24:27], s5 offen sc1 lds
    s_add_u32 s5, s19, 34816
    s_add_u32 m0, s18, 112640
    s_nop 0
    buffer_load_dwordx4 v6, s[24:27], s5 offen sc1 lds
    s_waitcnt vmcnt(11)
    s_barrier
    s_add_u32 s5, s19, 35840
    s_add_u32 m0, s18, 113664
    s_nop 0
    buffer_load_dwordx4 v6, s[24:27], s5 offen sc1 lds
    s_add_u32 s5, s22, 32768
    s_add_u32 m0, s21, 32768
    s_nop 0
    buffer_load_dwordx4 v5, s[24:27], s5 offen sc1 lds
    s_add_u32 s5, s22, 73728
    s_add_u32 m0, s21, 73728
    s_nop 0
    buffer_load_dwordx4 v5, s[24:27], s5 offen sc1 lds
    s_add_u32 s5, s19, 36864
    s_add_u32 m0, s18, 114688
    s_nop 0
    buffer_load_dwordx4 v6, s[24:27], s5 offen sc1 lds
    s_add_u32 s5, s19, 37888
    s_add_u32 m0, s18, 115712
    s_nop 0
    buffer_load_dwordx4 v6, s[24:27], s5 offen sc1 lds
    s_add_u32 s5, s19, 38912
    s_add_u32 m0, s18, 116736
    s_nop 0
    buffer_load_dwordx4 v6, s[24:27], s5 offen sc1 lds
    s_add_u32 s5, s19, 39936
    s_add_u32 m0, s18, 117760
    s_nop 0
    buffer_load_dwordx4 v6, s[24:27], s5 offen sc1 lds
    s_add_u32 s5, s22, 36864
    s_add_u32 m0, s21, 36864
    s_nop 0
    buffer_load_dwordx4 v5, s[24:27], s5 offen sc1 lds
    s_add_u32 s5, s22, 77824
    s_add_u32 m0, s21, 77824
    s_nop 0
    buffer_load_dwordx4 v5, s[24:27], s5 offen sc1 lds
    s_waitcnt vmcnt(18)
    s_barrier
    s_waitcnt vmcnt(12)
    s_barrier
    s_add_u32 s5, s22, 81920
    s_add_u32 m0, s21, 81920
    s_nop 0
    buffer_load_dwordx4 v5, s[24:27], s5 offen sc1 lds
    s_add_u32 s5, s22, 86016
    s_add_u32 m0, s21, 86016
    s_nop 0
    buffer_load_dwordx4 v5, s[24:27], s5 offen sc1 lds
    s_add_u32 s5, s22, 90112
    s_add_u32 m0, s21, 90112
    s_nop 0
    buffer_load_dwordx4 v5, s[24:27], s5 offen sc1 lds
    s_add_u32 s5, s22, 94208
    s_add_u32 m0, s21, 94208
    s_nop 0
    buffer_load_dwordx4 v5, s[24:27], s5 offen sc1 lds
    s_add_u32 s5, s22, 98304
    s_add_u32 m0, s21, 98304
    s_nop 0
    buffer_load_dwordx4 v5, s[24:27], s5 offen sc1 lds
    s_waitcnt vmcnt(11)
    s_barrier
    s_add_u32 s5, s22, 102400
    s_add_u32 m0, s21, 102400
    s_nop 0
    buffer_load_dwordx4 v5, s[24:27], s5 offen sc1 lds
    s_add_u32 s5, s22, 106496
    s_add_u32 m0, s21, 0
    s_nop 0
    buffer_load_dwordx4 v5, s[24:27], s5 offen sc1 lds
    s_add_u32 s5, s22, 110592
    s_add_u32 m0, s21, 40960
    s_nop 0
    buffer_load_dwordx4 v5, s[24:27], s5 offen sc1 lds
    s_add_u32 s5, s22, 114688
    s_add_u32 m0, s21, 4096
    s_nop 0
    buffer_load_dwordx4 v5, s[24:27], s5 offen sc1 lds
    s_add_u32 s5, s22, 118784
    s_add_u32 m0, s21, 45056
    s_nop 0
    buffer_load_dwordx4 v5, s[24:27], s5 offen sc1 lds
    s_waitcnt vmcnt(10)
    s_barrier
    s_waitcnt vmcnt(5)
    s_barrier
    s_waitcnt vmcnt(0)
    s_barrier
    s_branch K_EXIT
P2_MMX:
    s_and_b32 s38, s37, 3
    s_lshl_b32 s38, s38, 2
    s_and_b32 s39, s3, 3
    s_add_u32 s38, s38, s39
    s_lshr_b32 s39, s37, 2
    s_lshl_b32 s39, s39, 3
    s_lshr_b32 s4, s3, 2
    s_add_u32 s39, s39, s4
    s_lshl_b32 s45, s38, 4
    s_add_u32 s45, s45, s39
    s_lshl_b32 s45, s45, 7
    s_add_u32 s44, s45, 4620288
    s_add_u32 s45, s45, 4587520
    s_max_u32 s4, s36, 5
    s_mul_i32 s4, s4, 32
    s_add_u32 s44, s44, s4
    s_sub_u32 s44, s44, 160
    s_buffer_load_dword s62, s[24:27], s44 glc
    s_getpc_b64 s[4:5]
P2_PC:
    s_sub_u32 s4, s4, P2_PC-P2_PUB
    s_subb_u32 s5, s5, 0
    v_and_b32 v3, 63, v0
    v_lshlrev_b32 v3, 7, v3
    v_min_u32 v3, CODE_END-P2_PUB-4, v3
    global_load_dword v250, v3, s[4:5]
    s_barrier
P2_MMI:
P2_MM:
    s_and_b32 s38, s37, 3
    s_lshl_b32 s38, s38, 2
    s_and_b32 s39, s3, 3
    s_add_u32 s38, s38, s39
    s_lshr_b32 s39, s37, 2
    s_lshl_b32 s39, s39, 3
    s_lshr_b32 s4, s3, 2
    s_add_u32 s39, s39, s4
    s_lshl_b32 s45, s38, 4
    s_add_u32 s45, s45, s39
    s_lshl_b32 s45, s45, 7
    s_add_u32 s44, s45, 4620288
    s_add_u32 s45, s45, 4587520
    s_max_u32 s4, s36, 5
    s_mul_i32 s4, s4, 32
    s_add_u32 s44, s44, s4
    s_sub_u32 s44, s44, 160
    s_lshl_b32 s4, s38, 2
    s_add_u32 s4, s4, s36
    s_sub_u32 s4, s4, 4
    s_mul_i32 s20, s4, 40960
    s_mul_i32 s4, s4, 98304
    s_mul_i32 s5, s39, 192
    s_add_u32 s23, s4, s5
    s_add_u32 s22, s23, 49152
    v_and_b32 v6, 15, v1
    v_and_b32 v7, 48, v1
    v_lshlrev_b32 v3, 4, v6
    v_lshl_add_u32 v3, v7, 5, v3
    v_mul_u32_u24 v6, 0xc00, v6
    v_add_u32 v6, v6, v7
    v_add_u32 v4, 61440, v3
    s_mul_i32 s4, s36, 12288
    s_add_u32 s4, s4, 57344
    v_add_u32 v5, s4, v3
    v_min_u32 v2, 19, v1
    v_lshlrev_b32 v2, 7, v2
    v_mov_b32 v8, 155648
    s_mov_b32 s7, 40000
    s_branch P2_XF_C
P2_XF:
    s_sleep 2
P2_XF_1:
    s_sub_u32 s7, s7, 1
    s_cbranch_scc1 P2_XF_X
    s_buffer_load_dword s62, s[24:27], s44 glc
P2_XF_C:
    s_waitcnt lgkmcnt(0)
    s_cmp_lt_u32 s62, 20
    s_cbranch_scc1 P2_XF
P2_XF_X:
    s_branch P2_XW_E
    s_cmp_lg_u32 s36, 7
    s_cbranch_scc1 P2_XW
    s_mov_b32 s7, 40000
    s_branch P2_X_1
P2_X:
    s_sleep 2
P2_X_1:
    s_sub_u32 s7, s7, 1
    s_cbranch_scc1 P2_X_X
    s_buffer_load_dword s61, s[24:27], s44 glc
P2_X_C:
    s_waitcnt lgkmcnt(0)
    s_cmp_lt_u32 s61, 20
    s_cbranch_scc1 P2_X
P2_X_X:
    v_mov_b32 v7, 1
    ds_write_b32 v8, v7
    s_branch P2_XW_X
P2_XW_S:
    s_sleep 2
P2_XW:
    ds_read_b32 v7, v8
    s_waitcnt lgkmcnt(0)
    v_cmp_ne_u32 vcc, 0, v7
    s_cmp_eq_u64 vcc, -1
    s_cbranch_scc0 P2_XW_S
P2_XW_X:
P2_XW_E:
    buffer_load_dwordx4 v[96:99], v3, s[24:27], s20 offen offset:0 sc1
    buffer_load_dwordx4 v[100:103], v3, s[24:27], s20 offen offset:256 sc1
    s_cmp_ge_u32 s3, 21
    s_cbranch_scc1 P2_WSb_X
P2_WSb:
    ds_read_b32 v7, v8 offset:12
    s_waitcnt lgkmcnt(0)
    v_readfirstlane_b32 s4, v7
    s_cmp_lt_u32 s4, 4
    s_cbranch_scc1 P2_WSb
P2_WSb_X:
    buffer_load_dwordx4 v[104:107], v3, s[24:27], s20 offen offset:2048 sc1
    buffer_load_dwordx4 v[108:111], v3, s[24:27], s20 offen offset:2304 sc1
    s_add_u32 s20, s20, 4096
    buffer_load_dwordx4 v[112:115], v3, s[24:27], s20 offen offset:0 sc1
    buffer_load_dwordx4 v[116:119], v3, s[24:27], s20 offen offset:256 sc1
    buffer_load_dwordx4 v[120:123], v3, s[24:27], s20 offen offset:2048 sc1
    buffer_load_dwordx4 v[124:127], v3, s[24:27], s20 offen offset:2304 sc1
    s_add_u32 s20, s20, 4096
    s_cmp_ge_u32 s3, 21
    s_cbranch_scc1 P2_WSv_X
P2_WSv:
    ds_read_b32 v7, v8 offset:8
    s_waitcnt lgkmcnt(0)
    v_readfirstlane_b32 s4, v7
    s_cmp_lt_u32 s4, 4
    s_cbranch_scc1 P2_WSv
P2_WSv_X:
    buffer_load_dwordx4 v[128:131], v3, s[24:27], s20 offen offset:0 sc1
    buffer_load_dwordx4 v[132:135], v3, s[24:27], s20 offen offset:256 sc1
    buffer_load_dwordx4 v[136:139], v3, s[24:27], s20 offen offset:2048 sc1
    buffer_load_dwordx4 v[140:143], v3, s[24:27], s20 offen offset:2304 sc1
    s_add_u32 s20, s20, 4096
    buffer_load_dwordx4 v[144:147], v3, s[24:27], s20 offen offset:0 sc1
    buffer_load_dwordx4 v[148:151], v3, s[24:27], s20 offen offset:256 sc1
    buffer_load_dwordx4 v[152:155], v3, s[24:27], s20 offen offset:2048 sc1
    buffer_load_dwordx4 v[156:159], v3, s[24:27], s20 offen offset:2304 sc1
    s_add_u32 s20, s20, 4096
    buffer_load_dwordx4 v[160:163], v3, s[24:27], s20 offen offset:0 sc1
    buffer_load_dwordx4 v[164:167], v3, s[24:27], s20 offen offset:256 sc1
    buffer_load_dwordx4 v[168:171], v3, s[24:27], s20 offen offset:2048 sc1
    buffer_load_dwordx4 v[172:175], v3, s[24:27], s20 offen offset:2304 sc1
    s_add_u32 s20, s20, 4096
    buffer_load_dwordx4 v[176:179], v3, s[24:27], s20 offen offset:0 sc1
    buffer_load_dwordx4 v[180:183], v3, s[24:27], s20 offen offset:256 sc1
    buffer_load_dwordx4 v[184:187], v3, s[24:27], s20 offen offset:2048 sc1
    buffer_load_dwordx4 v[188:191], v3, s[24:27], s20 offen offset:2304 sc1
    s_add_u32 s20, s20, 4096
    buffer_load_dwordx4 v[192:195], v3, s[24:27], s20 offen offset:0 sc1
    buffer_load_dwordx4 v[196:199], v3, s[24:27], s20 offen offset:256 sc1
    buffer_load_dwordx4 v[200:203], v3, s[24:27], s20 offen offset:2048 sc1
    buffer_load_dwordx4 v[204:207], v3, s[24:27], s20 offen offset:2304 sc1
    s_add_u32 s20, s20, 4096
    s_barrier
    ds_read_b128 v[56:59], v3 offset:0
    ds_read_b128 v[60:63], v3 offset:40960
    ds_read_b128 v[64:67], v3 offset:256
    ds_read_b128 v[68:71], v3 offset:41216
    ds_read_b128 v[72:75], v3 offset:2048
    ds_read_b128 v[76:79], v3 offset:43008
    s_waitcnt vmcnt(26) lgkmcnt(5)
    v_mfma_f32_16x16x32_bf16 v[8:11], v[56:59], v[96:99], 0
    ds_read_b128 v[80:83], v3 offset:2304
    v_mfma_f32_16x16x32_bf16 v[16:19], v[56:59], v[100:103], 0
    s_waitcnt lgkmcnt(5)
    v_mfma_f32_16x16x32_bf16 v[24:27], v[60:63], v[96:99], 0
    ds_read_b128 v[84:87], v3 offset:43264
    v_mfma_f32_16x16x32_bf16 v[32:35], v[60:63], v[100:103], 0
    s_waitcnt lgkmcnt(5)
    v_mfma_f32_16x16x32_bf16 v[12:15], v[64:67], v[96:99], 0
    s_barrier
    ds_read_b128 v[56:59], v3 offset:4096
    v_mfma_f32_16x16x32_bf16 v[20:23], v[64:67], v[100:103], 0
    s_waitcnt lgkmcnt(5)
    v_mfma_f32_16x16x32_bf16 v[28:31], v[68:71], v[96:99], 0
    ds_read_b128 v[60:63], v3 offset:45056
    v_mfma_f32_16x16x32_bf16 v[36:39], v[68:71], v[100:103], 0
    s_waitcnt vmcnt(24) lgkmcnt(5)
    v_mfma_f32_16x16x32_bf16 v[8:11], v[72:75], v[104:107], v[8:11]
    ds_read_b128 v[64:67], v3 offset:4352
    v_mfma_f32_16x16x32_bf16 v[16:19], v[72:75], v[108:111], v[16:19]
    s_waitcnt lgkmcnt(5)
    v_mfma_f32_16x16x32_bf16 v[24:27], v[76:79], v[104:107], v[24:27]
    ds_read_b128 v[68:71], v3 offset:45312
    v_mfma_f32_16x16x32_bf16 v[32:35], v[76:79], v[108:111], v[32:35]
    s_waitcnt lgkmcnt(5)
    v_mfma_f32_16x16x32_bf16 v[12:15], v[80:83], v[104:107], v[12:15]
    ds_read_b128 v[72:75], v3 offset:6144
    v_mfma_f32_16x16x32_bf16 v[20:23], v[80:83], v[108:111], v[20:23]
    s_waitcnt lgkmcnt(5)
    v_mfma_f32_16x16x32_bf16 v[28:31], v[84:87], v[104:107], v[28:31]
    ds_read_b128 v[76:79], v3 offset:47104
    v_mfma_f32_16x16x32_bf16 v[36:39], v[84:87], v[108:111], v[36:39]
    s_waitcnt vmcnt(22) lgkmcnt(5)
    v_mfma_f32_16x16x32_bf16 v[8:11], v[56:59], v[112:115], v[8:11]
    ds_read_b128 v[80:83], v3 offset:6400
    v_mfma_f32_16x16x32_bf16 v[16:19], v[56:59], v[116:119], v[16:19]
    s_waitcnt lgkmcnt(5)
    v_mfma_f32_16x16x32_bf16 v[24:27], v[60:63], v[112:115], v[24:27]
    ds_read_b128 v[84:87], v3 offset:47360
    v_mfma_f32_16x16x32_bf16 v[32:35], v[60:63], v[116:119], v[32:35]
    s_waitcnt lgkmcnt(5)
    v_mfma_f32_16x16x32_bf16 v[12:15], v[64:67], v[112:115], v[12:15]
    s_barrier
    ds_read_b128 v[56:59], v3 offset:8192
    v_mfma_f32_16x16x32_bf16 v[20:23], v[64:67], v[116:119], v[20:23]
    s_waitcnt lgkmcnt(5)
    v_mfma_f32_16x16x32_bf16 v[28:31], v[68:71], v[112:115], v[28:31]
    ds_read_b128 v[60:63], v3 offset:49152
    v_mfma_f32_16x16x32_bf16 v[36:39], v[68:71], v[116:119], v[36:39]
    s_waitcnt vmcnt(20) lgkmcnt(5)
    v_mfma_f32_16x16x32_bf16 v[8:11], v[72:75], v[120:123], v[8:11]
    ds_read_b128 v[64:67], v3 offset:8448
    v_mfma_f32_16x16x32_bf16 v[16:19], v[72:75], v[124:127], v[16:19]
    s_waitcnt lgkmcnt(5)
    v_mfma_f32_16x16x32_bf16 v[24:27], v[76:79], v[120:123], v[24:27]
    ds_read_b128 v[68:71], v3 offset:49408
    v_mfma_f32_16x16x32_bf16 v[32:35], v[76:79], v[124:127], v[32:35]
    s_waitcnt lgkmcnt(5)
    v_mfma_f32_16x16x32_bf16 v[12:15], v[80:83], v[120:123], v[12:15]
    ds_read_b128 v[72:75], v3 offset:10240
    v_mfma_f32_16x16x32_bf16 v[20:23], v[80:83], v[124:127], v[20:23]
    s_waitcnt lgkmcnt(5)
    v_mfma_f32_16x16x32_bf16 v[28:31], v[84:87], v[120:123], v[28:31]
    ds_read_b128 v[76:79], v3 offset:51200
    v_mfma_f32_16x16x32_bf16 v[36:39], v[84:87], v[124:127], v[36:39]
    s_waitcnt vmcnt(18) lgkmcnt(5)
    v_mfma_f32_16x16x32_bf16 v[8:11], v[56:59], v[128:131], v[8:11]
    ds_read_b128 v[80:83], v3 offset:10496
    v_mfma_f32_16x16x32_bf16 v[16:19], v[56:59], v[132:135], v[16:19]
    s_waitcnt lgkmcnt(5)
    v_mfma_f32_16x16x32_bf16 v[24:27], v[60:63], v[128:131], v[24:27]
    ds_read_b128 v[84:87], v3 offset:51456
    v_mfma_f32_16x16x32_bf16 v[32:35], v[60:63], v[132:135], v[32:35]
    s_waitcnt lgkmcnt(5)
    v_mfma_f32_16x16x32_bf16 v[12:15], v[64:67], v[128:131], v[12:15]
    ds_read_b128 v[56:59], v3 offset:12288
    v_mfma_f32_16x16x32_bf16 v[20:23], v[64:67], v[132:135], v[20:23]
    s_waitcnt lgkmcnt(5)
    v_mfma_f32_16x16x32_bf16 v[28:31], v[68:71], v[128:131], v[28:31]
    ds_read_b128 v[60:63], v3 offset:53248
    v_mfma_f32_16x16x32_bf16 v[36:39], v[68:71], v[132:135], v[36:39]
    s_waitcnt vmcnt(16) lgkmcnt(5)
    v_mfma_f32_16x16x32_bf16 v[8:11], v[72:75], v[136:139], v[8:11]
    ds_read_b128 v[64:67], v3 offset:12544
    v_mfma_f32_16x16x32_bf16 v[16:19], v[72:75], v[140:143], v[16:19]
    s_waitcnt lgkmcnt(5)
    v_mfma_f32_16x16x32_bf16 v[24:27], v[76:79], v[136:139], v[24:27]
    ds_read_b128 v[68:71], v3 offset:53504
    v_mfma_f32_16x16x32_bf16 v[32:35], v[76:79], v[140:143], v[32:35]
    s_waitcnt lgkmcnt(5)
    v_mfma_f32_16x16x32_bf16 v[12:15], v[80:83], v[136:139], v[12:15]
    ds_read_b128 v[72:75], v3 offset:14336
    v_mfma_f32_16x16x32_bf16 v[20:23], v[80:83], v[140:143], v[20:23]
    s_waitcnt lgkmcnt(5)
    v_mfma_f32_16x16x32_bf16 v[28:31], v[84:87], v[136:139], v[28:31]
    ds_read_b128 v[76:79], v3 offset:55296
    v_mfma_f32_16x16x32_bf16 v[36:39], v[84:87], v[140:143], v[36:39]
    s_waitcnt vmcnt(14) lgkmcnt(5)
    v_mfma_f32_16x16x32_bf16 v[8:11], v[56:59], v[144:147], v[8:11]
    ds_read_b128 v[80:83], v3 offset:14592
    v_mfma_f32_16x16x32_bf16 v[16:19], v[56:59], v[148:151], v[16:19]
    s_waitcnt lgkmcnt(5)
    v_mfma_f32_16x16x32_bf16 v[24:27], v[60:63], v[144:147], v[24:27]
    ds_read_b128 v[84:87], v3 offset:55552
    v_mfma_f32_16x16x32_bf16 v[32:35], v[60:63], v[148:151], v[32:35]
    s_waitcnt lgkmcnt(5)
    v_mfma_f32_16x16x32_bf16 v[12:15], v[64:67], v[144:147], v[12:15]
    s_barrier
    ds_read_b128 v[56:59], v3 offset:16384
    v_mfma_f32_16x16x32_bf16 v[20:23], v[64:67], v[148:151], v[20:23]
    s_waitcnt lgkmcnt(5)
    v_mfma_f32_16x16x32_bf16 v[28:31], v[68:71], v[144:147], v[28:31]
    ds_read_b128 v[60:63], v3 offset:57344
    v_mfma_f32_16x16x32_bf16 v[36:39], v[68:71], v[148:151], v[36:39]
    s_waitcnt vmcnt(12) lgkmcnt(5)
    v_mfma_f32_16x16x32_bf16 v[8:11], v[72:75], v[152:155], v[8:11]
    ds_read_b128 v[64:67], v3 offset:16640
    v_mfma_f32_16x16x32_bf16 v[16:19], v[72:75], v[156:159], v[16:19]
    s_waitcnt lgkmcnt(5)
    v_mfma_f32_16x16x32_bf16 v[24:27], v[76:79], v[152:155], v[24:27]
    ds_read_b128 v[68:71], v3 offset:57600
    v_mfma_f32_16x16x32_bf16 v[32:35], v[76:79], v[156:159], v[32:35]
    s_waitcnt lgkmcnt(5)
    v_mfma_f32_16x16x32_bf16 v[12:15], v[80:83], v[152:155], v[12:15]
    ds_read_b128 v[72:75], v3 offset:18432
    v_mfma_f32_16x16x32_bf16 v[20:23], v[80:83], v[156:159], v[20:23]
    s_waitcnt lgkmcnt(5)
    v_mfma_f32_16x16x32_bf16 v[28:31], v[84:87], v[152:155], v[28:31]
    ds_read_b128 v[76:79], v3 offset:59392
    v_mfma_f32_16x16x32_bf16 v[36:39], v[84:87], v[156:159], v[36:39]
    s_waitcnt vmcnt(10) lgkmcnt(5)
    v_mfma_f32_16x16x32_bf16 v[8:11], v[56:59], v[160:163], v[8:11]
    ds_read_b128 v[80:83], v3 offset:18688
    v_mfma_f32_16x16x32_bf16 v[16:19], v[56:59], v[164:167], v[16:19]
    s_waitcnt lgkmcnt(5)
    v_mfma_f32_16x16x32_bf16 v[24:27], v[60:63], v[160:163], v[24:27]
    ds_read_b128 v[84:87], v3 offset:59648
    v_mfma_f32_16x16x32_bf16 v[32:35], v[60:63], v[164:167], v[32:35]
    s_waitcnt lgkmcnt(5)
    v_mfma_f32_16x16x32_bf16 v[12:15], v[64:67], v[160:163], v[12:15]
    ds_read_b128 v[56:59], v3 offset:20480
    v_mfma_f32_16x16x32_bf16 v[20:23], v[64:67], v[164:167], v[20:23]
    s_waitcnt lgkmcnt(5)
    v_mfma_f32_16x16x32_bf16 v[28:31], v[68:71], v[160:163], v[28:31]
    ds_read_b128 v[60:63], v4 offset:0
    v_mfma_f32_16x16x32_bf16 v[36:39], v[68:71], v[164:167], v[36:39]
    s_waitcnt vmcnt(8) lgkmcnt(5)
    v_mfma_f32_16x16x32_bf16 v[8:11], v[72:75], v[168:171], v[8:11]
    ds_read_b128 v[64:67], v3 offset:20736
    v_mfma_f32_16x16x32_bf16 v[16:19], v[72:75], v[172:175], v[16:19]
    s_waitcnt lgkmcnt(5)
    v_mfma_f32_16x16x32_bf16 v[24:27], v[76:79], v[168:171], v[24:27]
    ds_read_b128 v[68:71], v4 offset:256
    v_mfma_f32_16x16x32_bf16 v[32:35], v[76:79], v[172:175], v[32:35]
    s_waitcnt lgkmcnt(5)
    v_mfma_f32_16x16x32_bf16 v[12:15], v[80:83], v[168:171], v[12:15]
    ds_read_b128 v[72:75], v3 offset:22528
    v_mfma_f32_16x16x32_bf16 v[20:23], v[80:83], v[172:175], v[20:23]
    s_waitcnt lgkmcnt(5)
    v_mfma_f32_16x16x32_bf16 v[28:31], v[84:87], v[168:171], v[28:31]
    ds_read_b128 v[76:79], v4 offset:2048
    v_mfma_f32_16x16x32_bf16 v[36:39], v[84:87], v[172:175], v[36:39]
    s_waitcnt vmcnt(6) lgkmcnt(5)
    v_mfma_f32_16x16x32_bf16 v[8:11], v[56:59], v[176:179], v[8:11]
    ds_read_b128 v[80:83], v3 offset:22784
    v_mfma_f32_16x16x32_bf16 v[16:19], v[56:59], v[180:183], v[16:19]
    s_waitcnt lgkmcnt(5)
    v_mfma_f32_16x16x32_bf16 v[24:27], v[60:63], v[176:179], v[24:27]
    ds_read_b128 v[84:87], v4 offset:2304
    v_mfma_f32_16x16x32_bf16 v[32:35], v[60:63], v[180:183], v[32:35]
    s_waitcnt lgkmcnt(5)
    v_mfma_f32_16x16x32_bf16 v[12:15], v[64:67], v[176:179], v[12:15]
    s_barrier
    ds_read_b128 v[56:59], v3 offset:24576
    v_mfma_f32_16x16x32_bf16 v[20:23], v[64:67], v[180:183], v[20:23]
    s_waitcnt lgkmcnt(5)
    v_mfma_f32_16x16x32_bf16 v[28:31], v[68:71], v[176:179], v[28:31]
    ds_read_b128 v[60:63], v4 offset:4096
    v_mfma_f32_16x16x32_bf16 v[36:39], v[68:71], v[180:183], v[36:39]
    s_waitcnt vmcnt(4) lgkmcnt(5)
    v_mfma_f32_16x16x32_bf16 v[8:11], v[72:75], v[184:187], v[8:11]
    ds_read_b128 v[64:67], v3 offset:24832
    v_mfma_f32_16x16x32_bf16 v[16:19], v[72:75], v[188:191], v[16:19]
    s_waitcnt lgkmcnt(5)
    v_mfma_f32_16x16x32_bf16 v[24:27], v[76:79], v[184:187], v[24:27]
    ds_read_b128 v[68:71], v4 offset:4352
    v_mfma_f32_16x16x32_bf16 v[32:35], v[76:79], v[188:191], v[32:35]
    s_waitcnt lgkmcnt(5)
    v_mfma_f32_16x16x32_bf16 v[12:15], v[80:83], v[184:187], v[12:15]
    ds_read_b128 v[72:75], v3 offset:26624
    v_mfma_f32_16x16x32_bf16 v[20:23], v[80:83], v[188:191], v[20:23]
    s_waitcnt lgkmcnt(5)
    v_mfma_f32_16x16x32_bf16 v[28:31], v[84:87], v[184:187], v[28:31]
    ds_read_b128 v[76:79], v4 offset:6144
    v_mfma_f32_16x16x32_bf16 v[36:39], v[84:87], v[188:191], v[36:39]
    s_waitcnt vmcnt(2) lgkmcnt(5)
    v_mfma_f32_16x16x32_bf16 v[8:11], v[56:59], v[192:195], v[8:11]
    ds_read_b128 v[80:83], v3 offset:26880
    v_mfma_f32_16x16x32_bf16 v[16:19], v[56:59], v[196:199], v[16:19]
    s_waitcnt lgkmcnt(5)
    v_mfma_f32_16x16x32_bf16 v[24:27], v[60:63], v[192:195], v[24:27]
    ds_read_b128 v[84:87], v4 offset:6400
    v_mfma_f32_16x16x32_bf16 v[32:35], v[60:63], v[196:199], v[32:35]
    s_waitcnt lgkmcnt(5)
    v_mfma_f32_16x16x32_bf16 v[12:15], v[64:67], v[192:195], v[12:15]
    s_barrier
    ds_read_b128 v[56:59], v3 offset:28672
    v_mfma_f32_16x16x32_bf16 v[20:23], v[64:67], v[196:199], v[20:23]
    ds_read_b128 v[208:211], v5 offset:0
    s_waitcnt lgkmcnt(6)
    v_mfma_f32_16x16x32_bf16 v[28:31], v[68:71], v[192:195], v[28:31]
    ds_read_b128 v[60:63], v4 offset:8192
    v_mfma_f32_16x16x32_bf16 v[36:39], v[68:71], v[196:199], v[36:39]
    ds_read_b128 v[212:215], v5 offset:256
    s_waitcnt vmcnt(0) lgkmcnt(7)
    v_mfma_f32_16x16x32_bf16 v[8:11], v[72:75], v[200:203], v[8:11]
    ds_read_b128 v[64:67], v3 offset:28928
    v_mfma_f32_16x16x32_bf16 v[16:19], v[72:75], v[204:207], v[16:19]
    s_waitcnt lgkmcnt(7)
    v_mfma_f32_16x16x32_bf16 v[24:27], v[76:79], v[200:203], v[24:27]
    ds_read_b128 v[68:71], v4 offset:8448
    v_mfma_f32_16x16x32_bf16 v[32:35], v[76:79], v[204:207], v[32:35]
    s_waitcnt lgkmcnt(7)
    v_mfma_f32_16x16x32_bf16 v[12:15], v[80:83], v[200:203], v[12:15]
    ds_read_b128 v[72:75], v3 offset:30720
    v_mfma_f32_16x16x32_bf16 v[20:23], v[80:83], v[204:207], v[20:23]
    ds_read_b128 v[216:219], v5 offset:2048
    s_waitcnt lgkmcnt(8)
    v_mfma_f32_16x16x32_bf16 v[28:31], v[84:87], v[200:203], v[28:31]
    ds_read_b128 v[76:79], v4 offset:10240
    v_mfma_f32_16x16x32_bf16 v[36:39], v[84:87], v[204:207], v[36:39]
    ds_read_b128 v[220:223], v5 offset:2304
    s_waitcnt lgkmcnt(6)
    v_mfma_f32_16x16x32_bf16 v[8:11], v[56:59], v[208:211], v[8:11]
    ds_read_b128 v[80:83], v3 offset:30976
    v_mfma_f32_16x16x32_bf16 v[16:19], v[56:59], v[212:215], v[16:19]
    s_waitcnt lgkmcnt(8)
    v_mfma_f32_16x16x32_bf16 v[24:27], v[60:63], v[208:211], v[24:27]
    ds_read_b128 v[84:87], v4 offset:10496
    v_mfma_f32_16x16x32_bf16 v[32:35], v[60:63], v[212:215], v[32:35]
    s_waitcnt lgkmcnt(7)
    v_mfma_f32_16x16x32_bf16 v[12:15], v[64:67], v[208:211], v[12:15]
    s_barrier
    ds_read_b128 v[56:59], v3 offset:32768
    v_mfma_f32_16x16x32_bf16 v[20:23], v[64:67], v[212:215], v[20:23]
    ds_read_b128 v[224:227], v5 offset:4096
    s_waitcnt lgkmcnt(8)
    v_mfma_f32_16x16x32_bf16 v[28:31], v[68:71], v[208:211], v[28:31]
    ds_read_b128 v[60:63], v4 offset:12288
    v_mfma_f32_16x16x32_bf16 v[36:39], v[68:71], v[212:215], v[36:39]
    ds_read_b128 v[228:231], v5 offset:4352
    s_waitcnt lgkmcnt(6)
    v_mfma_f32_16x16x32_bf16 v[8:11], v[72:75], v[216:219], v[8:11]
    ds_read_b128 v[64:67], v3 offset:33024
    v_mfma_f32_16x16x32_bf16 v[16:19], v[72:75], v[220:223], v[16:19]
    s_waitcnt lgkmcnt(8)
    v_mfma_f32_16x16x32_bf16 v[24:27], v[76:79], v[216:219], v[24:27]
    ds_read_b128 v[68:71], v4 offset:12544
    v_mfma_f32_16x16x32_bf16 v[32:35], v[76:79], v[220:223], v[32:35]
    s_waitcnt lgkmcnt(7)
    v_mfma_f32_16x16x32_bf16 v[12:15], v[80:83], v[216:219], v[12:15]
    ds_read_b128 v[72:75], v3 offset:34816
    v_mfma_f32_16x16x32_bf16 v[20:23], v[80:83], v[220:223], v[20:23]
    ds_read_b128 v[232:235], v5 offset:6144
    s_waitcnt lgkmcnt(8)
    v_mfma_f32_16x16x32_bf16 v[28:31], v[84:87], v[216:219], v[28:31]
    ds_read_b128 v[76:79], v4 offset:14336
    v_mfma_f32_16x16x32_bf16 v[36:39], v[84:87], v[220:223], v[36:39]
    ds_read_b128 v[236:239], v5 offset:6400
    s_waitcnt lgkmcnt(6)
    v_mfma_f32_16x16x32_bf16 v[8:11], v[56:59], v[224:227], v[8:11]
    ds_read_b128 v[80:83], v3 offset:35072
    v_mfma_f32_16x16x32_bf16 v[16:19], v[56:59], v[228:231], v[16:19]
    s_waitcnt lgkmcnt(8)
    v_mfma_f32_16x16x32_bf16 v[24:27], v[60:63], v[224:227], v[24:27]
    ds_read_b128 v[84:87], v4 offset:14592
    v_mfma_f32_16x16x32_bf16 v[32:35], v[60:63], v[228:231], v[32:35]
    s_waitcnt lgkmcnt(7)
    v_mfma_f32_16x16x32_bf16 v[12:15], v[64:67], v[224:227], v[12:15]
    s_barrier
    ds_read_b128 v[56:59], v3 offset:36864
    v_mfma_f32_16x16x32_bf16 v[20:23], v[64:67], v[228:231], v[20:23]
    ds_read_b128 v[240:243], v5 offset:8192
    s_waitcnt lgkmcnt(8)
    v_mfma_f32_16x16x32_bf16 v[28:31], v[68:71], v[224:227], v[28:31]
    ds_read_b128 v[60:63], v4 offset:16384
    v_mfma_f32_16x16x32_bf16 v[36:39], v[68:71], v[228:231], v[36:39]
    ds_read_b128 v[244:247], v5 offset:8448
    s_waitcnt lgkmcnt(6)
    v_mfma_f32_16x16x32_bf16 v[8:11], v[72:75], v[232:235], v[8:11]
    ds_read_b128 v[64:67], v3 offset:37120
    v_mfma_f32_16x16x32_bf16 v[16:19], v[72:75], v[236:239], v[16:19]
    s_waitcnt lgkmcnt(8)
    v_mfma_f32_16x16x32_bf16 v[24:27], v[76:79], v[232:235], v[24:27]
    ds_read_b128 v[68:71], v4 offset:16640
    v_mfma_f32_16x16x32_bf16 v[32:35], v[76:79], v[236:239], v[32:35]
    s_waitcnt lgkmcnt(7)
    v_mfma_f32_16x16x32_bf16 v[12:15], v[80:83], v[232:235], v[12:15]
    ds_read_b128 v[72:75], v3 offset:38912
    v_mfma_f32_16x16x32_bf16 v[20:23], v[80:83], v[236:239], v[20:23]
    ds_read_b128 v[248:251], v5 offset:10240
    s_waitcnt lgkmcnt(8)
    v_mfma_f32_16x16x32_bf16 v[28:31], v[84:87], v[232:235], v[28:31]
    ds_read_b128 v[76:79], v4 offset:18432
    v_mfma_f32_16x16x32_bf16 v[36:39], v[84:87], v[236:239], v[36:39]
    ds_read_b128 v[252:255], v5 offset:10496
    s_waitcnt lgkmcnt(6)
    v_mfma_f32_16x16x32_bf16 v[8:11], v[56:59], v[240:243], v[8:11]
    ds_read_b128 v[80:83], v3 offset:39168
    v_mfma_f32_16x16x32_bf16 v[16:19], v[56:59], v[244:247], v[16:19]
    s_waitcnt lgkmcnt(8)
    v_mfma_f32_16x16x32_bf16 v[24:27], v[60:63], v[240:243], v[24:27]
    ds_read_b128 v[84:87], v4 offset:18688
    v_mfma_f32_16x16x32_bf16 v[32:35], v[60:63], v[244:247], v[32:35]
    s_waitcnt lgkmcnt(7)
    v_mfma_f32_16x16x32_bf16 v[12:15], v[64:67], v[240:243], v[12:15]
    s_barrier
    ds_read_b128 v[56:59], v4 offset:20480
    v_mfma_f32_16x16x32_bf16 v[20:23], v[64:67], v[244:247], v[20:23]
    s_waitcnt lgkmcnt(7)
    v_mfma_f32_16x16x32_bf16 v[28:31], v[68:71], v[240:243], v[28:31]
    ds_read_b128 v[60:63], v4 offset:20736
    v_mfma_f32_16x16x32_bf16 v[36:39], v[68:71], v[244:247], v[36:39]
    s_waitcnt lgkmcnt(4)
    v_mfma_f32_16x16x32_bf16 v[8:11], v[72:75], v[248:251], v[8:11]
    ds_read_b128 v[64:67], v4 offset:22528
    v_mfma_f32_16x16x32_bf16 v[16:19], v[72:75], v[252:255], v[16:19]
    s_waitcnt lgkmcnt(6)
    v_mfma_f32_16x16x32_bf16 v[24:27], v[76:79], v[248:251], v[24:27]
    ds_read_b128 v[68:71], v4 offset:22784
    v_mfma_f32_16x16x32_bf16 v[32:35], v[76:79], v[252:255], v[32:35]
    s_waitcnt lgkmcnt(5)
    v_mfma_f32_16x16x32_bf16 v[12:15], v[80:83], v[248:251], v[12:15]
    ds_read_b128 v[72:75], v4 offset:24576
    v_mfma_f32_16x16x32_bf16 v[20:23], v[80:83], v[252:255], v[20:23]
    s_waitcnt lgkmcnt(5)
    v_mfma_f32_16x16x32_bf16 v[28:31], v[84:87], v[248:251], v[28:31]
    ds_read_b128 v[76:79], v4 offset:24832
    v_mfma_f32_16x16x32_bf16 v[36:39], v[84:87], v[252:255], v[36:39]
    s_waitcnt lgkmcnt(5)
    v_mfma_f32_16x16x32_bf16 v[40:43], v[56:59], v[96:99], 0
    ds_read_b128 v[80:83], v4 offset:26624
    v_mfma_f32_16x16x32_bf16 v[48:51], v[56:59], v[100:103], 0
    s_waitcnt lgkmcnt(5)
    v_mfma_f32_16x16x32_bf16 v[44:47], v[60:63], v[96:99], 0
    ds_read_b128 v[84:87], v4 offset:26880
    v_mfma_f32_16x16x32_bf16 v[52:55], v[60:63], v[100:103], 0
    v_cvt_pk_bf16_f32 v88, v8, v9
    v_cvt_pk_bf16_f32 v89, v10, v11
    s_waitcnt lgkmcnt(5)
    v_mfma_f32_16x16x32_bf16 v[40:43], v[64:67], v[104:107], v[40:43]
    ds_read_b128 v[56:59], v4 offset:28672
    v_mfma_f32_16x16x32_bf16 v[48:51], v[64:67], v[108:111], v[48:51]
    v_cvt_pk_bf16_f32 v90, v12, v13
    v_cvt_pk_bf16_f32 v91, v14, v15
    s_waitcnt lgkmcnt(5)
    v_mfma_f32_16x16x32_bf16 v[44:47], v[68:71], v[104:107], v[44:47]
    ds_read_b128 v[60:63], v4 offset:28928
    v_mfma_f32_16x16x32_bf16 v[52:55], v[68:71], v[108:111], v[52:55]
    buffer_store_dwordx4 v[88:91], v6, s[96:99], s23 offen offset:0 sc1
    s_waitcnt lgkmcnt(5)
    v_mfma_f32_16x16x32_bf16 v[40:43], v[72:75], v[112:115], v[40:43]
    ds_read_b128 v[64:67], v4 offset:30720
    v_mfma_f32_16x16x32_bf16 v[48:51], v[72:75], v[116:119], v[48:51]
    v_cvt_pk_bf16_f32 v92, v16, v17
    v_cvt_pk_bf16_f32 v93, v18, v19
    s_waitcnt lgkmcnt(5)
    v_mfma_f32_16x16x32_bf16 v[44:47], v[76:79], v[112:115], v[44:47]
    ds_read_b128 v[68:71], v4 offset:30976
    v_mfma_f32_16x16x32_bf16 v[52:55], v[76:79], v[116:119], v[52:55]
    v_cvt_pk_bf16_f32 v94, v20, v21
    v_cvt_pk_bf16_f32 v95, v22, v23
    s_waitcnt lgkmcnt(5)
    v_mfma_f32_16x16x32_bf16 v[40:43], v[80:83], v[120:123], v[40:43]
    ds_read_b128 v[72:75], v4 offset:32768
    v_mfma_f32_16x16x32_bf16 v[48:51], v[80:83], v[124:127], v[48:51]
    buffer_store_dwordx4 v[92:95], v6, s[96:99], s22 offen offset:0 sc1
    s_waitcnt lgkmcnt(5)
    v_mfma_f32_16x16x32_bf16 v[44:47], v[84:87], v[120:123], v[44:47]
    ds_read_b128 v[76:79], v4 offset:33024
    v_mfma_f32_16x16x32_bf16 v[52:55], v[84:87], v[124:127], v[52:55]
    s_waitcnt lgkmcnt(5)
    v_mfma_f32_16x16x32_bf16 v[40:43], v[56:59], v[128:131], v[40:43]
    ds_read_b128 v[80:83], v4 offset:34816
    v_mfma_f32_16x16x32_bf16 v[48:51], v[56:59], v[132:135], v[48:51]
    s_waitcnt lgkmcnt(5)
    v_mfma_f32_16x16x32_bf16 v[44:47], v[60:63], v[128:131], v[44:47]
    ds_read_b128 v[84:87], v4 offset:35072
    v_mfma_f32_16x16x32_bf16 v[52:55], v[60:63], v[132:135], v[52:55]
    s_waitcnt lgkmcnt(5)
    v_mfma_f32_16x16x32_bf16 v[40:43], v[64:67], v[136:139], v[40:43]
    ds_read_b128 v[56:59], v4 offset:36864
    v_mfma_f32_16x16x32_bf16 v[48:51], v[64:67], v[140:143], v[48:51]
    s_waitcnt lgkmcnt(5)
    v_mfma_f32_16x16x32_bf16 v[44:47], v[68:71], v[136:139], v[44:47]
    ds_read_b128 v[60:63], v4 offset:37120
    v_mfma_f32_16x16x32_bf16 v[52:55], v[68:71], v[140:143], v[52:55]
    v_cvt_pk_bf16_f32 v88, v24, v25
    v_cvt_pk_bf16_f32 v89, v26, v27
    s_waitcnt lgkmcnt(5)
    v_mfma_f32_16x16x32_bf16 v[40:43], v[72:75], v[144:147], v[40:43]
    ds_read_b128 v[64:67], v4 offset:38912
    v_mfma_f32_16x16x32_bf16 v[48:51], v[72:75], v[148:151], v[48:51]
    v_cvt_pk_bf16_f32 v90, v28, v29
    v_cvt_pk_bf16_f32 v91, v30, v31
    s_waitcnt lgkmcnt(5)
    v_mfma_f32_16x16x32_bf16 v[44:47], v[76:79], v[144:147], v[44:47]
    ds_read_b128 v[68:71], v4 offset:39168
    v_mfma_f32_16x16x32_bf16 v[52:55], v[76:79], v[148:151], v[52:55]
    buffer_store_dwordx4 v[88:91], v6, s[96:99], s23 offen offset:64 sc1
    s_waitcnt lgkmcnt(5)
    v_mfma_f32_16x16x32_bf16 v[40:43], v[80:83], v[152:155], v[40:43]
    s_barrier
    ds_read_b128 v[72:75], v4 offset:40960
    v_mfma_f32_16x16x32_bf16 v[48:51], v[80:83], v[156:159], v[48:51]
    v_cvt_pk_bf16_f32 v92, v32, v33
    v_cvt_pk_bf16_f32 v93, v34, v35
    s_waitcnt lgkmcnt(5)
    v_mfma_f32_16x16x32_bf16 v[44:47], v[84:87], v[152:155], v[44:47]
    ds_read_b128 v[76:79], v4 offset:41216
    v_mfma_f32_16x16x32_bf16 v[52:55], v[84:87], v[156:159], v[52:55]
    v_cvt_pk_bf16_f32 v94, v36, v37
    v_cvt_pk_bf16_f32 v95, v38, v39
    s_waitcnt lgkmcnt(5)
    v_mfma_f32_16x16x32_bf16 v[40:43], v[56:59], v[160:163], v[40:43]
    ds_read_b128 v[80:83], v4 offset:43008
    v_mfma_f32_16x16x32_bf16 v[48:51], v[56:59], v[164:167], v[48:51]
    buffer_store_dwordx4 v[92:95], v6, s[96:99], s22 offen offset:64 sc1
    s_waitcnt lgkmcnt(5)
    v_mfma_f32_16x16x32_bf16 v[44:47], v[60:63], v[160:163], v[44:47]
    ds_read_b128 v[84:87], v4 offset:43264
    v_mfma_f32_16x16x32_bf16 v[52:55], v[60:63], v[164:167], v[52:55]
    s_waitcnt lgkmcnt(5)
    v_mfma_f32_16x16x32_bf16 v[40:43], v[64:67], v[168:171], v[40:43]
    ds_read_b128 v[56:59], v3 offset:0
    v_mfma_f32_16x16x32_bf16 v[48:51], v[64:67], v[172:175], v[48:51]
    s_waitcnt lgkmcnt(5)
    v_mfma_f32_16x16x32_bf16 v[44:47], v[68:71], v[168:171], v[44:47]
    ds_read_b128 v[60:63], v3 offset:256
    v_mfma_f32_16x16x32_bf16 v[52:55], v[68:71], v[172:175], v[52:55]
    s_waitcnt lgkmcnt(5)
    v_mfma_f32_16x16x32_bf16 v[40:43], v[72:75], v[176:179], v[40:43]
    ds_read_b128 v[64:67], v3 offset:2048
    v_mfma_f32_16x16x32_bf16 v[48:51], v[72:75], v[180:183], v[48:51]
    s_waitcnt lgkmcnt(5)
    v_mfma_f32_16x16x32_bf16 v[44:47], v[76:79], v[176:179], v[44:47]
    ds_read_b128 v[68:71], v3 offset:2304
    v_mfma_f32_16x16x32_bf16 v[52:55], v[76:79], v[180:183], v[52:55]
    s_waitcnt lgkmcnt(5)
    v_mfma_f32_16x16x32_bf16 v[40:43], v[80:83], v[184:187], v[40:43]
    ds_read_b128 v[72:75], v3 offset:40960
    v_mfma_f32_16x16x32_bf16 v[48:51], v[80:83], v[188:191], v[48:51]
    s_waitcnt lgkmcnt(5)
    v_mfma_f32_16x16x32_bf16 v[44:47], v[84:87], v[184:187], v[44:47]
    ds_read_b128 v[76:79], v3 offset:41216
    v_mfma_f32_16x16x32_bf16 v[52:55], v[84:87], v[188:191], v[52:55]
    s_waitcnt lgkmcnt(5)
    v_mfma_f32_16x16x32_bf16 v[40:43], v[56:59], v[192:195], v[40:43]
    ds_read_b128 v[80:83], v3 offset:43008
    v_mfma_f32_16x16x32_bf16 v[48:51], v[56:59], v[196:199], v[48:51]
    s_waitcnt lgkmcnt(5)
    v_mfma_f32_16x16x32_bf16 v[44:47], v[60:63], v[192:195], v[44:47]
    ds_read_b128 v[84:87], v3 offset:43264
    v_mfma_f32_16x16x32_bf16 v[52:55], v[60:63], v[196:199], v[52:55]
    s_waitcnt lgkmcnt(5)
    v_mfma_f32_16x16x32_bf16 v[40:43], v[64:67], v[200:203], v[40:43]
    ds_read_b128 v[56:59], v3 offset:4096
    v_mfma_f32_16x16x32_bf16 v[48:51], v[64:67], v[204:207], v[48:51]
    s_waitcnt lgkmcnt(5)
    v_mfma_f32_16x16x32_bf16 v[44:47], v[68:71], v[200:203], v[44:47]
    ds_read_b128 v[60:63], v3 offset:4352
    v_mfma_f32_16x16x32_bf16 v[52:55], v[68:71], v[204:207], v[52:55]
    s_waitcnt lgkmcnt(5)
    v_mfma_f32_16x16x32_bf16 v[40:43], v[72:75], v[208:211], v[40:43]
    ds_read_b128 v[64:67], v3 offset:6144
    v_mfma_f32_16x16x32_bf16 v[48:51], v[72:75], v[212:215], v[48:51]
    s_waitcnt lgkmcnt(5)
    v_mfma_f32_16x16x32_bf16 v[44:47], v[76:79], v[208:211], v[44:47]
    ds_read_b128 v[68:71], v3 offset:6400
    v_mfma_f32_16x16x32_bf16 v[52:55], v[76:79], v[212:215], v[52:55]
    s_waitcnt lgkmcnt(5)
    v_mfma_f32_16x16x32_bf16 v[40:43], v[80:83], v[216:219], v[40:43]
    ds_read_b128 v[72:75], v3 offset:45056
    v_mfma_f32_16x16x32_bf16 v[48:51], v[80:83], v[220:223], v[48:51]
    s_waitcnt lgkmcnt(5)
    v_mfma_f32_16x16x32_bf16 v[44:47], v[84:87], v[216:219], v[44:47]
    ds_read_b128 v[76:79], v3 offset:45312
    v_mfma_f32_16x16x32_bf16 v[52:55], v[84:87], v[220:223], v[52:55]
    s_waitcnt lgkmcnt(5)
    v_mfma_f32_16x16x32_bf16 v[40:43], v[56:59], v[224:227], v[40:43]
    ds_read_b128 v[80:83], v3 offset:47104
    v_mfma_f32_16x16x32_bf16 v[48:51], v[56:59], v[228:231], v[48:51]
    s_waitcnt lgkmcnt(5)
    v_mfma_f32_16x16x32_bf16 v[44:47], v[60:63], v[224:227], v[44:47]
    ds_read_b128 v[84:87], v3 offset:47360
    v_mfma_f32_16x16x32_bf16 v[52:55], v[60:63], v[228:231], v[52:55]
    s_waitcnt lgkmcnt(5)
    v_mfma_f32_16x16x32_bf16 v[40:43], v[64:67], v[232:235], v[40:43]
    v_mfma_f32_16x16x32_bf16 v[48:51], v[64:67], v[236:239], v[48:51]
    s_waitcnt lgkmcnt(4)
    v_mfma_f32_16x16x32_bf16 v[44:47], v[68:71], v[232:235], v[44:47]
    v_mfma_f32_16x16x32_bf16 v[52:55], v[68:71], v[236:239], v[52:55]
    s_waitcnt lgkmcnt(3)
    v_mfma_f32_16x16x32_bf16 v[40:43], v[72:75], v[240:243], v[40:43]
    v_mfma_f32_16x16x32_bf16 v[48:51], v[72:75], v[244:247], v[48:51]
    s_waitcnt lgkmcnt(2)
    v_mfma_f32_16x16x32_bf16 v[44:47], v[76:79], v[240:243], v[44:47]
    v_mfma_f32_16x16x32_bf16 v[52:55], v[76:79], v[244:247], v[52:55]
    s_waitcnt lgkmcnt(1)
    v_mfma_f32_16x16x32_bf16 v[40:43], v[80:83], v[248:251], v[40:43]
    v_mfma_f32_16x16x32_bf16 v[48:51], v[80:83], v[252:255], v[48:51]
    s_waitcnt lgkmcnt(0)
    v_mfma_f32_16x16x32_bf16 v[44:47], v[84:87], v[248:251], v[44:47]
    v_mfma_f32_16x16x32_bf16 v[52:55], v[84:87], v[252:255], v[52:55]
    s_nop 7
    v_cvt_pk_bf16_f32 v56, v40, v41
    v_cvt_pk_bf16_f32 v57, v42, v43
    v_cvt_pk_bf16_f32 v58, v44, v45
    v_cvt_pk_bf16_f32 v59, v46, v47
    buffer_store_dwordx4 v[56:59], v6, s[96:99], s23 offen offset:128 sc1
    v_cvt_pk_bf16_f32 v60, v48, v49
    v_cvt_pk_bf16_f32 v61, v50, v51
    v_cvt_pk_bf16_f32 v62, v52, v53
    v_cvt_pk_bf16_f32 v63, v54, v55
    buffer_store_dwordx4 v[60:63], v6, s[96:99], s22 offen offset:128 sc1
K_EXIT:
    s_endpgm
CODE_END:
.section .rodata,"a"
.p2align 6
.amdhsa_kernel standalone__weight_only_int_quip__prompt_kernel
  .amdhsa_next_free_vgpr 256
  .amdhsa_next_free_sgpr 100
  .amdhsa_accum_offset 256
  .amdhsa_group_segment_fixed_size 0
  .amdhsa_kernarg_size 72
  .amdhsa_user_sgpr_count 2
  .amdhsa_user_sgpr_kernarg_segment_ptr 1
  .amdhsa_system_sgpr_workgroup_id_x 1
  .amdhsa_float_denorm_mode_32 3
.end_amdhsa_kernel
```
